```python
import torch

def _softmax(x, axis=-1):
    return torch.softmax(x, dim=axis)
def _gelu(x):
    return torch.nn.functional.gelu(x, approximate="tanh")
def _silu(x):
    return torch.nn.functional.silu(x)
def _sigmoid(x):
    return torch.sigmoid(x)
def _layernorm(x, axis=-1, eps=1e-5):
    m = x.mean(dim=axis, keepdim=True)
    v = x.var(dim=axis, keepdim=True, unbiased=False)
    return (x - m) / torch.sqrt(v + eps)
def _scatter_add(tgt, idx, src, axis=0):
    return tgt.clone().index_add_(axis, idx, src)
def _segment_sum(src, seg, n):
    out = torch.zeros((n,) + src.shape[1:], dtype=src.dtype)
    return out.index_add_(0, seg, src)
def _pad(x, pw):
    flat = tuple(v for pair in reversed(pw) for v in pair)
    return torch.nn.functional.pad(x, flat)

kernel_name = 'standalone__cheap_equivariant_egnn__graph'

def setup_inputs():

    _w = (lambda a: (lambda t: t.to(torch.bfloat16) if t.is_floating_point() else t)(torch.as_tensor(a)))
    N, deg, D, De = 25000, 16, 128, max(0, 1)
    E = N * deg
    return {
        "h": _w((lambda *s: torch.randn(*s, dtype=torch.bfloat16) * 0.2)(N, D)),
        "pos": _w((lambda *s: torch.randn(*s, dtype=torch.bfloat16) * 0.8)(N, 3)),
        "e_attr": _w((lambda *s: torch.randn(*s, dtype=torch.bfloat16) * 0.8)(E, De)),
        "src": _w((lambda lo, hi, *s: torch.randint(lo, hi, s))(0, N, E).to(torch.int64)),
        "dst": _w((lambda lo, hi, *s: torch.randint(lo, hi, s))(0, N, E).to(torch.int64)),
        "w_e": _w(0.1 * (lambda *s: torch.randn(*s, dtype=torch.bfloat16) * 0.8)(2 * D + 1 + De, D)),
        "w_x": _w(0.1 * (lambda *s: torch.randn(*s, dtype=torch.bfloat16) * 0.2)(D, 1)),
        "w_h": _w(0.1 * (lambda *s: torch.randn(*s, dtype=torch.bfloat16) * 0.2)(2 * D, D)),
    }

def reference(h, pos, e_attr, src, dst, w_e, w_x, w_h):
    N, D = h.shape[0], h.shape[1]
    diff = pos[dst] - pos[src]
    dist2 = torch.sum(diff * diff, axis=-1, keepdims=True)
    e_in = torch.concatenate([h[dst], h[src], dist2, e_attr], axis=-1)
    m_ij = _silu(e_in @ w_e)
    coord_scale = m_ij @ w_x
    pos_new = pos + _segment_sum(diff * coord_scale, dst, N)
    m_i = _segment_sum(m_ij, dst, N)
    h_new = h + _silu(torch.concatenate([h, m_i], axis=-1) @ w_h)
    return h_new, pos_new
```

```asm
; @launch kernel=standalone__cheap_equivariant_egnn__graph_kernel grid=(256,1,1) block=(512,1,1) lds=160832
.amdgcn_target "amdgcn-amd-amdhsa--gfx950"
.text
.globl standalone__cheap_equivariant_egnn__graph_kernel
.p2align 8
.type standalone__cheap_equivariant_egnn__graph_kernel,@function
standalone__cheap_equivariant_egnn__graph_kernel:
    s_cmp_ge_u32 s2, 256
    s_cbranch_scc1 K2_END
    s_load_dwordx16 s[4:19], s[0:1], 0
    s_load_dwordx2 s[20:21], s[0:1], 64
    s_load_dwordx2 s[22:23], s[0:1], 80
    s_bfe_u32 s3, s2, 0x30003
    v_lshl_add_u32 v224, v0, 3, s3
    v_lshlrev_b32 v224, 7, v224
    s_getpc_b64 s[72:73]
K2_BEG:
    v_cmp_gt_u32 vcc, K2_END-K2_BEG, v224
    v_mov_b32 v225, 0
    v_lshl_add_u64 v[224:225], v[224:225], 0, s[72:73]
    s_and_b64 exec, exec, vcc
    s_cbranch_execz K2_BEG1
    global_load_dword v236, v[224:225], off
K2_BEG1:
    s_mov_b64 exec, -1
    v_lshrrev_b32 v224, 6, v0
    v_and_b32 v1, 63, v0
    v_readfirstlane_b32 s40, v224
    s_and_b32 s62, s2, 7
    s_lshr_b32 s63, s2, 3
    s_lshl_b32 s41, s62, 5
    s_add_u32 s41, s41, s63
    s_mov_b32 s3, s41
    s_mul_i32 s41, s41, 98
    v_and_b32 v247, 255, v0
    v_lshlrev_b32 v242, 4, v247
    v_lshlrev_b32 v243, 4, v1
    v_mov_b32 v184, 0
    v_mov_b32 v185, 0
    v_mov_b32 v186, 0
    v_mov_b32 v187, 0
    v_lshrrev_b32 v2, 5, v1
    s_mov_b32 s42, 0
    s_mov_b32 s43, 24
    s_mov_b32 s56, 0
    s_mov_b32 s54, 0
    s_mov_b32 s61, 0
    v_lshlrev_b32 v227, 3, v1
    v_add_u32 v238, 141056, v243
    ds_write_b64 v227, v[184:185] offset:42496
    ds_write_b128 v238, v[184:187]
    v_lshrrev_b32 v224, 4, v1
    v_lshlrev_b32 v224, 6, v224
    v_xor_b32 v237, v224, v243
    v_lshlrev_b32 v58, 4, v0
    v_add_u32 v58, -1024, v58
    v_lshrrev_b32 v224, 1, v58
    s_mul_i32 s62, s2, 6256
    s_lshr_b32 s63, s62, 1
    s_mov_b32 s66, 0xd600000
    s_cmp_lg_u32 s40, 0
    s_waitcnt lgkmcnt(0)
    s_cbranch_scc1 K2_PART
    s_load_dword s85, s[6:7], 149996
    s_load_dwordx2 s[80:81], s[22:23], s66
    s_barrier
    s_mov_b32 s24, s14
    s_mov_b32 s25, s15
    s_mov_b32 s26, 0x10200
    s_mov_b32 s27, 0x20000
    v_lshlrev_b32 v9, 1, v1
    s_mov_b32 s63, 65536
    buffer_load_ushort v192, v9, s[24:27], s63 offen offset:0
    buffer_load_ushort v193, v9, s[24:27], s63 offen offset:256
    buffer_load_ushort v194, v9, s[24:27], s63 offen offset:128
    buffer_load_ushort v195, v9, s[24:27], s63 offen offset:384
    s_mov_b32 s24, s16
    s_mov_b32 s25, s17
    s_mov_b32 s26, 0x100
    s_mov_b32 s27, 0x20000
    v_and_b32 v8, 31, v1
    v_lshlrev_b32 v9, 1, v8
    buffer_load_ushort v196, v9, s[24:27], 0 offen offset:0
    buffer_load_ushort v197, v9, s[24:27], 0 offen offset:64
    buffer_load_ushort v198, v9, s[24:27], 0 offen offset:128
    buffer_load_ushort v199, v9, s[24:27], 0 offen offset:192
    s_mov_b32 s24, s6
    s_mov_b32 s25, s7
    s_mov_b32 s26, 0x249f0
    s_mov_b32 s27, 0x20000
    s_mul_i32 s62, s41, 6
    v_mul_u32_u24 v224, 6, v1
    buffer_load_ushort v208, v224, s[24:27], s62 offen offset:0
    buffer_load_ushort v209, v224, s[24:27], s62 offen offset:2
    buffer_load_ushort v210, v224, s[24:27], s62 offen offset:4
    buffer_load_ushort v212, v224, s[24:27], s62 offen offset:384
    buffer_load_ushort v213, v224, s[24:27], s62 offen offset:386
    buffer_load_ushort v214, v224, s[24:27], s62 offen offset:388
    s_mov_b32 s46, 0x40000000
    s_cmp_ge_u32 s2, 32
    s_cbranch_scc1 K2_L0
    s_mov_b32 s24, s18
    s_mov_b32 s25, s19
    s_mov_b32 s26, 0x10000
    s_mov_b32 s27, 0x20000
    s_bfe_u32 s65, s2, 0x10002
    s_lshl_b32 s65, s65, 6
    s_and_b32 s63, s2, 3
    s_lshl3_add_u32 s63, s63, s65
    s_add_u32 s63, s63, 128
    s_lshl_b32 s63, s63, 8
    s_bfe_u32 s65, s2, 0x10004
    s_lshl_b32 s65, s65, 7
    s_add_u32 s63, s63, s65
    s_bfe_u32 s65, s2, 0x10003
    s_lshl1_add_u32 s63, s65, s63
    s_lshl_b32 s46, s2, 10
    s_add_u32 s46, s46, 0xd480000
    v_lshlrev_b32 v9, 2, v8
    v_lshl_add_u32 v9, v2, 10, v9
    v_add_u32 v10, 8192, v9
    buffer_load_ushort v200, v9, s[24:27], s63 offen offset:0
    buffer_load_ushort v201, v10, s[24:27], s63 offen offset:0
    buffer_load_ushort v202, v9, s[24:27], s63 offen offset:256
    buffer_load_ushort v203, v10, s[24:27], s63 offen offset:256
    buffer_load_ushort v204, v9, s[24:27], s63 offen offset:512
    buffer_load_ushort v205, v10, s[24:27], s63 offen offset:512
    buffer_load_ushort v206, v9, s[24:27], s63 offen offset:768
    buffer_load_ushort v207, v10, s[24:27], s63 offen offset:768
K2_L0:
    s_mov_b32 s32, s22
    s_mov_b32 s33, s23
    s_mov_b32 s34, 0x10000000
    s_mov_b32 s35, 0x20000
    s_mov_b32 s24, s14
    s_mov_b32 s25, s15
    s_mov_b32 s26, 0x10200
    s_mov_b32 s27, 0x20000
    s_mov_b32 s36, s4
    s_mov_b32 s37, s5
    s_mov_b32 s38, 0x61a800
    s_mov_b32 s39, 0x20000
    v_and_b32 v224, 48, v1
    v_xor_b32 v60, v224, v243
    v_xor_b32 v61, 64, v60
    v_xor_b32 v62, 128, v60
    v_xor_b32 v63, 192, v60
    s_lshl_b32 s62, s41, 8
    s_add_u32 s48, s62, 24576
    s_mov_b32 m0, 80128
    s_mov_b32 s63, 32768
K2_LW:
    buffer_load_dwordx4 v237, s[24:27], s63 offen offset:0 lds
    buffer_load_dwordx4 v237, s[24:27], s63 offen offset:1024 lds
    buffer_load_dwordx4 v237, s[24:27], s63 offen offset:2048 lds
    buffer_load_dwordx4 v237, s[24:27], s63 offen offset:3072 lds
    s_add_u32 m0, m0, 4096
    s_add_u32 s63, s63, 4096
    s_cmp_lt_u32 s63, 65536
    s_cbranch_scc1 K2_LW
    s_mov_b32 m0, 114432
    s_nop 0
K2_LH:
    buffer_load_dwordx4 v60, s[36:39], s62 offen offset:0  lds
    buffer_load_dwordx4 v61, s[36:39], s62 offen offset:1024  lds
    buffer_load_dwordx4 v62, s[36:39], s62 offen offset:2048  lds
    buffer_load_dwordx4 v63, s[36:39], s62 offen offset:3072  lds
    s_add_u32 m0, m0, 4096
    s_add_u32 s62, s62, 4096
    s_cmp_lt_u32 s62, s48
    s_cbranch_scc1 K2_LH
    buffer_load_dwordx4 v60, s[36:39], s62 offen offset:0  lds
    buffer_load_dwordx4 v61, s[36:39], s62 offen offset:1024  lds
    s_branch K2_LOAD
K2_PART:
    s_setprio 2
    s_mov_b32 s24, s12
    s_mov_b32 s25, s13
    s_mov_b32 s26, 0x186a00
    s_mov_b32 s27, 0x20000
    buffer_load_dwordx4 v[20:23], v58, s[24:27], s62 offen
    s_mov_b32 s28, s10
    s_mov_b32 s29, s11
    s_mov_b32 s30, 0x186a00
    s_mov_b32 s31, 0x20000
    s_mov_b32 s36, s8
    s_mov_b32 s37, s9
    s_mov_b32 s38, 0xc3500
    s_mov_b32 s39, 0x20000
    s_barrier
    buffer_load_dwordx4 v[24:27], v58, s[28:31], s62 offen
    buffer_load_dwordx2 v[28:29], v224, s[36:39], s63 offen
    s_load_dword s85, s[6:7], 149996
    s_load_dwordx2 s[80:81], s[22:23], s66
    s_mov_b32 s32, s22
    s_mov_b32 s33, s23
    s_mov_b32 s34, 0x10000000
    s_mov_b32 s35, 0x20000
    s_sub_u32 s63, 1600000, s62
    s_min_u32 s63, s63, 6256
    v_cmp_gt_u32 s[70:71], s63, v58
    v_mov_b32 v57, 1
    v_and_b32 v224, 31, v1
    v_lshlrev_b32 v225, 2, v224
    v_mul_u32_u24 v226, 928, v2
    s_mov_b32 s62, 114432
    v_add3_u32 v3, v225, v226, s62
    v_mov_b32 v222, 0x3f80
    v_mov_b32 v223, 0
    v_mov_b32 v216, 0x3f003f00
    v_mov_b32 v217, 0
    v_mov_b32 v221, 0x3f80
    v_mov_b32 v14, 0xdddd
    v_mov_b32 v12, 0x4afa0000
    s_mov_b32 s67, 0x44c040c0
    s_mov_b32 s74, 512
    s_mov_b32 s75, 256
    s_mov_b32 s76, -2048
    s_mov_b32 s77, -1025
    s_mov_b32 s68, 0x3f80
    s_mov_b32 s69, 0x3f800000
    v_cvt_f32_u32 v225, v225
    v_mul_f32 v225, 0x00800000, v225
    v_lshrrev_b32 v225, 16, v225
    v_cmp_gt_u32 vcc, 32, v1
    v_mov_b32 v226, 0x8800480
    s_mul_i32 s62, s40, 5248
    s_add_u32 s62, s62, 72448
    s_add_u32 s63, s62, 1024
    v_cndmask_b32 v218, 0, v226, vcc
    v_cndmask_b32 v219, 0, v225, vcc
    v_add_u32 v4, s62, v243
    v_lshl_add_u32 v5, v1, 5, s63
    v_and_b32 v225, 0xf0, v243
    v_add_u32 v225, s62, v225
    v_add_u32 v226, -16, v1
    v_cmp_gt_u32 vcc, 32, v226
    v_mov_b32 v226, 0x80000
    v_bfe_u32 v227, v1, 2, 2
    v_cndmask_b32 v7, v225, v226, vcc
    v_cmp_eq_u32 vcc, 0, v1
    s_lshl_b32 s64, s40, 2
    v_mov_b32 v225, s64
    v_cndmask_b32 v15, v226, v225, vcc
    v_cndmask_b32 v18, v226, v184, vcc
    v_lshl_add_u32 v227, v2, 3, v227
    v_lshlrev_b32 v227, 5, v227
    v_and_b32 v225, 1, v1
    v_lshl_add_u32 v227, v225, 3, v227
    v_and_b32 v226, 16, v1
    v_add_u32 v227, v227, v226
    v_bfe_u32 v224, v1, 1, 1
    v_mul_u32_u24 v224, 2176, v224
    v_add3_u32 v6, v224, v227, s63
    v_lshrrev_b32 v226, 4, v226
    v_lshl_add_u32 v225, v225, 1, v226
    v_mul_u32_u24 v13, 0x5555, v225
    v_bfe_u32 v225, v1, 1, 3
    v_lshlrev_b32 v227, 2, v2
    v_xor_b32 v225, v225, v227
    v_cmp_eq_u32 vcc, 0, v225
    s_nop 1
    v_cndmask_b32 v180, 0, v222, vcc
    v_cmp_eq_u32 vcc, 1, v225
    s_nop 1
    v_cndmask_b32 v181, 0, v222, vcc
    v_cmp_eq_u32 vcc, 2, v225
    s_nop 1
    v_cndmask_b32 v182, 0, v222, vcc
    v_cmp_eq_u32 vcc, 3, v225
    s_nop 1
    v_cndmask_b32 v183, 0, v222, vcc
    v_add_u32 v225, 143104, v58
    s_mul_i32 s62, s2, 12800
    s_add_u32 s62, s62, 0xd000000
    s_add_u32 s24, s22, s62
    s_addc_u32 s25, s23, 0
    s_mov_b32 s26, 0x30e0
    s_mov_b32 s27, 0x20000
    s_mov_b32 s62, 42800
    s_mov_b32 s63, -196
    s_mov_b32 s64, 141056
    s_mov_b32 s65, 0xffff0000
    s_waitcnt vmcnt(2)
    v_mul_u32_u24 v48, s62, v20
    v_mul_u32_u24 v49, s62, v21
    v_mul_u32_u24 v50, s62, v22
    v_mul_u32_u24 v51, s62, v23
    v_lshrrev_b32 v48, 22, v48
    v_lshrrev_b32 v49, 22, v49
    v_lshrrev_b32 v50, 22, v50
    v_lshrrev_b32 v51, 22, v51
    v_lshl_add_u32 v32, v48, 2, s64
    v_lshl_add_u32 v33, v49, 2, s64
    v_lshl_add_u32 v34, v50, 2, s64
    v_lshl_add_u32 v35, v51, 2, s64
    s_mov_b64 exec, s[70:71]
    s_cbranch_execz K2_P1
    ds_add_rtn_u32 v36, v32, v57
    ds_add_rtn_u32 v37, v33, v57
    ds_add_rtn_u32 v38, v34, v57
    ds_add_rtn_u32 v39, v35, v57
K2_P1:
    s_mov_b64 exec, -1
    ds_add_u32 v18, v222 offset:42788
    v_lshlrev_b32 v20, 1, v20
    v_mad_i32_i24 v20, v48, s63, v20
    v_and_b32 v224, 12, v20
    v_and_b32 v225, 14, v20
    v_add_u32 v224, v224, v225
    v_lshl_or_b32 v20, v224, 8, v20
    v_lshlrev_b32 v21, 1, v21
    v_mad_i32_i24 v21, v49, s63, v21
    v_and_b32 v224, 12, v21
    v_and_b32 v225, 14, v21
    v_add_u32 v224, v224, v225
    v_lshl_or_b32 v21, v224, 8, v21
    v_lshlrev_b32 v22, 1, v22
    v_mad_i32_i24 v22, v50, s63, v22
    v_and_b32 v224, 12, v22
    v_and_b32 v225, 14, v22
    v_add_u32 v224, v224, v225
    v_lshl_or_b32 v22, v224, 8, v22
    v_lshlrev_b32 v23, 1, v23
    v_mad_i32_i24 v23, v51, s63, v23
    v_and_b32 v224, 12, v23
    v_and_b32 v225, 14, v23
    v_add_u32 v224, v224, v225
    v_lshl_or_b32 v23, v224, 8, v23
    s_waitcnt vmcnt(0)
    v_cvt_f32_ubyte0 v40, v24
    v_or_b32 v24, 0x8000, v24
    v_cvt_f32_ubyte1 v24, v24
    v_cvt_pk_bf16_f32 v40, v40, v24
    v_lshl_or_b32 v41, v28, 16, v20
    v_cvt_f32_ubyte0 v42, v25
    v_or_b32 v25, 0x8000, v25
    v_cvt_f32_ubyte1 v25, v25
    v_cvt_pk_bf16_f32 v42, v42, v25
    v_and_or_b32 v43, v28, s65, v21
    v_cvt_f32_ubyte0 v44, v26
    v_or_b32 v26, 0x8000, v26
    v_cvt_f32_ubyte1 v26, v26
    v_cvt_pk_bf16_f32 v44, v44, v26
    v_lshl_or_b32 v45, v29, 16, v22
    v_cvt_f32_ubyte0 v46, v27
    v_or_b32 v27, 0x8000, v27
    v_cvt_f32_ubyte1 v27, v27
    v_cvt_pk_bf16_f32 v46, v46, v27
    v_and_or_b32 v47, v29, s65, v23
    s_setprio 1
K2_P2:
    ds_read_b32 v224, v184 offset:42788
    ds_read_b128 v[48:51], v238
    s_waitcnt lgkmcnt(0)
    v_readfirstlane_b32 s62, v224
    s_cmp_lt_u32 s62, 113792
    s_cbranch_scc1 K2_P2
    s_setprio 2
    s_and_b32 s85, s85, 0xffff0000
    s_mov_b32 s84, 149994
    s_mul_hi_u32 s62, s80, 0x2c9277b5
    s_mul_i32 s63, s81, 0x2c9277b5
    s_add_u32 s63, s63, s62
    s_mul_i32 s62, s80, 0x2c9277b5
    s_add_u32 s80, s62, 0xac564b05
    s_addc_u32 s81, s63, 0x14057b7e
    s_waitcnt lgkmcnt(0)
    v_add_u32 v54, v48, v49
    v_add_u32 v55, v54, v50
    v_add_u32 v53, v55, v51
    v_mov_b32 v56, v53
    s_nop 1
    v_add_u32_dpp v56, v56, v56 row_shr:1 row_mask:0xf bank_mask:0xf
    s_nop 1
    v_add_u32_dpp v56, v56, v56 row_shr:2 row_mask:0xf bank_mask:0xf
    s_nop 1
    v_add_u32_dpp v56, v56, v56 row_shr:4 row_mask:0xf bank_mask:0xf
    s_nop 1
    v_add_u32_dpp v56, v56, v56 row_shr:8 row_mask:0xf bank_mask:0xf
    s_nop 1
    v_add_u32_dpp v56, v56, v56 row_bcast:15 row_mask:0xa bank_mask:0xf
    s_nop 1
    v_add_u32_dpp v56, v56, v56 row_bcast:31 row_mask:0xc bank_mask:0xf
    v_sub_u32 v52, v56, v53
    v_add_u32 v53, v52, v48
    v_add_u32 v54, v52, v54
    v_add_u32 v55, v52, v55
    s_mov_b32 s64, 143104
    v_lshl_add_u32 v48, v52, 3, s64
    v_lshl_add_u32 v49, v53, 3, s64
    v_lshl_add_u32 v50, v54, 3, s64
    v_lshl_add_u32 v51, v55, 3, s64
    ds_write_b128 v238, v[48:51] offset:1024
    ds_read_b32 v20, v32 offset:1024
    ds_read_b32 v21, v33 offset:1024
    ds_read_b32 v22, v34 offset:1024
    ds_read_b32 v23, v35 offset:1024
    v_add_u32 v227, 143104, v242
    s_waitcnt lgkmcnt(0)
    s_mov_b64 exec, s[70:71]
    s_cbranch_execz K2_P3
    v_lshl_add_u32 v36, v36, 3, v20
    ds_write_b64 v36, v[40:41] offset:0
    v_lshl_add_u32 v37, v37, 3, v21
    ds_write_b64 v37, v[42:43] offset:0
    v_lshl_add_u32 v38, v38, 3, v22
    ds_write_b64 v38, v[44:45] offset:0
    v_lshl_add_u32 v39, v39, 3, v23
    ds_write_b64 v39, v[46:47] offset:0
K2_P3:
    s_mov_b64 exec, -1
    ds_add_u32 v18, v222 offset:42792
    s_cmp_lt_u32 s40, 4
    s_cbranch_scc1 K2_G0
    s_setprio 1
K2_P4:
    ds_read_b32 v224, v184 offset:42792
    s_waitcnt lgkmcnt(0)
    v_readfirstlane_b32 s62, v224
    s_cmp_lt_u32 s62, 113792
    s_cbranch_scc1 K2_P4
    s_setprio 2
    ds_read_b128 v[84:87], v227 offset:0
    ds_read_b128 v[88:91], v227 offset:4096
    ds_read_b128 v[92:95], v227 offset:8192
    ds_read_b128 v[96:99], v227 offset:12288
    s_waitcnt lgkmcnt(3)
    buffer_store_dwordx4 v[84:87], v242, s[24:27], 0 offen sc1
    s_mov_b32 s62, 4096
    s_waitcnt lgkmcnt(2)
    buffer_store_dwordx4 v[88:91], v242, s[24:27], s62 offen sc1
    s_mov_b32 s62, 8192
    s_waitcnt lgkmcnt(1)
    buffer_store_dwordx4 v[92:95], v242, s[24:27], s62 offen sc1
    s_mov_b32 s62, 12288
    s_waitcnt lgkmcnt(0)
    buffer_store_dwordx4 v[96:99], v242, s[24:27], s62 offen sc1
K2_P41:
    ds_read_b32 v224, v184 offset:42796
    s_waitcnt lgkmcnt(0)
    v_readfirstlane_b32 s62, v224
    s_cmp_lt_u32 s62, 16256
    s_cbranch_scc1 K2_P41
    s_bitcmp0_b32 s40, 1
    s_cselect_b32 s36, s14, s18
    s_cselect_b32 s37, s15, s19
    s_cselect_b32 s65, 0, 47360
    s_mov_b32 s38, 32768
    s_mov_b32 s39, 0x20000
    s_and_b32 s64, s40, 1
    s_lshl_b32 s64, s64, 14
    s_add_u32 m0, s64, s65
    s_nop 0
    buffer_load_dwordx4 v237, s[36:39], s64 offen offset:0 lds
    buffer_load_dwordx4 v237, s[36:39], s64 offen offset:1024 lds
    buffer_load_dwordx4 v237, s[36:39], s64 offen offset:2048 lds
    buffer_load_dwordx4 v237, s[36:39], s64 offen offset:3072 lds
    s_add_u32 s64, s64, 4096
    s_add_u32 m0, s64, s65
    s_nop 0
    buffer_load_dwordx4 v237, s[36:39], s64 offen offset:0 lds
    buffer_load_dwordx4 v237, s[36:39], s64 offen offset:1024 lds
    buffer_load_dwordx4 v237, s[36:39], s64 offen offset:2048 lds
    buffer_load_dwordx4 v237, s[36:39], s64 offen offset:3072 lds
    s_add_u32 s64, s64, 4096
    s_add_u32 m0, s64, s65
    s_nop 0
    buffer_load_dwordx4 v237, s[36:39], s64 offen offset:0 lds
    buffer_load_dwordx4 v237, s[36:39], s64 offen offset:1024 lds
    buffer_load_dwordx4 v237, s[36:39], s64 offen offset:2048 lds
    buffer_load_dwordx4 v237, s[36:39], s64 offen offset:3072 lds
    s_add_u32 s64, s64, 4096
    s_add_u32 m0, s64, s65
    s_nop 0
    buffer_load_dwordx4 v237, s[36:39], s64 offen offset:0 lds
    buffer_load_dwordx4 v237, s[36:39], s64 offen offset:1024 lds
    buffer_load_dwordx4 v237, s[36:39], s64 offen offset:2048 lds
    buffer_load_dwordx4 v237, s[36:39], s64 offen offset:3072 lds
    v_lshl_or_b32 v24, v53, 16, v52
    v_lshl_or_b32 v25, v55, 16, v54
    s_and_b32 s62, s81, 0xffff0000
    v_or_b32 v26, s62, v56
    v_mov_b32 v27, s80
    v_lshrrev_b32 v226, 2, v1
    v_mul_u32_u24 v226, 16640, v226
    v_and_b32 v225, 63, v243
    v_add_u32 v226, v226, v225
    s_mul_i32 s63, s2, 64
    s_add_u32 s63, s63, 0xd420000
    s_waitcnt vmcnt(16)
    s_mov_b64 exec, 1
    ds_add_rtn_u32 v224, v184, v222 offset:42824
    s_waitcnt lgkmcnt(0)
    v_readfirstlane_b32 s62, v224
    s_mov_b64 exec, -1
    s_cmp_lg_u32 s62, 48768
    s_cbranch_scc1 K2_P5
    buffer_store_dwordx4 v[24:27], v226, s[32:35], s63 offen sc1
    s_waitcnt vmcnt(1)
    ds_add_u32 v18, v222 offset:42808
    s_waitcnt vmcnt(0)
    ds_add_u32 v18, v222 offset:42824
    s_branch K2_P51
K2_P5:
    s_waitcnt vmcnt(0)
    ds_add_u32 v18, v222 offset:42808
K2_P51:
    s_mov_b32 s36, s4
    s_mov_b32 s37, s5
    s_mov_b32 s38, 0x61a800
    s_mov_b32 s39, 0x20000
    s_mov_b32 s28, s6
    s_mov_b32 s29, s7
    s_mov_b32 s30, 0x249f0
    s_mov_b32 s31, 0x20000
    s_mov_b32 s24, s22
    s_mov_b32 s25, s23
    s_mov_b32 s26, 0xc61a800
    s_mov_b32 s27, 0x20000
    s_setprio 0
K2_P61:
    ds_read_b32 v224, v184 offset:42828
    s_waitcnt lgkmcnt(0)
    v_readfirstlane_b32 s62, v224
    s_cmp_lt_u32 s62, 65024
    s_cbranch_scc1 K2_P61
K2_P6:
    ds_read_b32 v224, v184 offset:42824
    s_waitcnt lgkmcnt(0)
    v_readfirstlane_b32 s62, v224
    s_cmp_lt_u32 s62, 81280
    s_cbranch_scc1 K2_P6
    s_setprio 2
K2_OFF:
    s_lshr_b32 s62, s3, 4
    s_mul_i32 s62, s62, 16640
    s_bfe_u32 s63, s3, 0x20002
    s_lshl4_add_u32 s62, s63, s62
    s_add_u32 s63, s62, 0xd420000
    v_mul_u32_u24 v227, 64, v247
    s_lshr_b32 s64, s81, 16
    s_mov_b32 s87, 1048576
K2_O1:
    buffer_load_dwordx4 v[228:231], v227, s[32:35], s63 offen sc1
K2_O11:
    s_waitcnt vmcnt(0)
K2_O12:
    v_lshrrev_b32 v224, 16, v230
    v_cmp_ne_u32 vcc, s80, v231
    v_cmp_ne_u32 s[72:73], s64, v224
    s_or_b64 exec, vcc, s[72:73]
    s_cbranch_execz K2_O2
    s_sub_u32 s87, s87, 1
    s_cbranch_scc0 K2_O1
    v_mov_b32 v228, 0
    v_mov_b32 v229, 0
    v_mov_b32 v230, 0
K2_O2:
    s_mov_b64 exec, -1
    s_bitcmp0_b32 s3, 1
    s_cbranch_scc1 K2_O3
    v_mov_b32 v228, v229
    v_mov_b32 v229, v230
K2_O3:
    s_lshl_b32 s62, s3, 4
    v_alignbit_b32 v244, v229, v228, s62
    v_and_b32 v227, 60, v1
    v_lshrrev_b32 v245, 16, v244
    ds_bpermute_b32 v228, v227, v244 offset:0
    ds_bpermute_b32 v229, v227, v244 offset:64
    ds_bpermute_b32 v230, v227, v244 offset:128
    ds_bpermute_b32 v231, v227, v244 offset:192
    v_and_b32 v224, 0xffff, v244
    v_add_u32 v224, s42, v224
    v_sub_u32 v245, v245, v224
    v_cmp_lt_i32 s[72:73], s43, v245
    v_and_b32 v225, 3, v1
    v_lshlrev_b32 v225, 1, v225
    v_sub_u32 v245, s43, v225
    v_add_u32 v225, s42, v225
    v_mul_u32_u24 v226, 3200, v227
    s_and_b32 s62, s40, 3
    s_mul_i32 s62, s62, 819200
    s_add_u32 s62, s62, 0xd000000
    s_add_u32 s63, s62, 204800
    s_add_u32 s64, s62, 409600
    s_add_u32 s65, s62, 614400
    s_waitcnt lgkmcnt(3)
    v_add_u32_sdwa v224, v225, v228 dst_sel:DWORD dst_unused:UNUSED_PAD src0_sel:DWORD src1_sel:WORD_0
    v_subrev_u32_sdwa v232, v224, v228 dst_sel:DWORD dst_unused:UNUSED_PAD src0_sel:DWORD src1_sel:WORD_1
    v_lshl_add_u32 v228, v224, 3, v226
    v_min_i32 v232, v232, v245
    s_waitcnt lgkmcnt(2)
    v_add_u32_sdwa v224, v225, v229 dst_sel:DWORD dst_unused:UNUSED_PAD src0_sel:DWORD src1_sel:WORD_0
    v_subrev_u32_sdwa v233, v224, v229 dst_sel:DWORD dst_unused:UNUSED_PAD src0_sel:DWORD src1_sel:WORD_1
    v_lshl_add_u32 v229, v224, 3, v226
    v_min_i32 v233, v233, v245
    s_waitcnt lgkmcnt(1)
    v_add_u32_sdwa v224, v225, v230 dst_sel:DWORD dst_unused:UNUSED_PAD src0_sel:DWORD src1_sel:WORD_0
    v_subrev_u32_sdwa v234, v224, v230 dst_sel:DWORD dst_unused:UNUSED_PAD src0_sel:DWORD src1_sel:WORD_1
    v_lshl_add_u32 v230, v224, 3, v226
    v_min_i32 v234, v234, v245
    s_waitcnt lgkmcnt(0)
    v_add_u32_sdwa v224, v225, v231 dst_sel:DWORD dst_unused:UNUSED_PAD src0_sel:DWORD src1_sel:WORD_0
    v_subrev_u32_sdwa v235, v224, v231 dst_sel:DWORD dst_unused:UNUSED_PAD src0_sel:DWORD src1_sel:WORD_1
    v_lshl_add_u32 v231, v224, 3, v226
    v_min_i32 v235, v235, v245
    s_cmp_lg_u64 s[72:73], 0
    s_cbranch_scc1 K2_LONG
K2_EL:
    v_max3_i32 v224, v232, v233, v234
    v_max_i32 v224, v224, v235
    v_cmp_lt_i32 vcc, 16, v224
    s_cbranch_vccnz K2_EP
K2_EP1:
    v_cmp_lt_i32 vcc, 0, v232
    v_cmp_lt_i32 s[70:71], 8, v232
    s_or_b64 exec, vcc, 1
    buffer_load_dwordx4 v[20:23], v228, s[32:35], s62 offen offset:0 sc1
    s_or_b64 exec, s[70:71], 1
    buffer_load_dwordx4 v[24:27], v228, s[32:35], s62 offen offset:64 sc1
    s_mov_b64 exec, -1
    v_cmp_lt_i32 vcc, 0, v233
    v_cmp_lt_i32 s[70:71], 8, v233
    s_or_b64 exec, vcc, 1
    buffer_load_dwordx4 v[32:35], v229, s[32:35], s63 offen offset:0 sc1
    s_or_b64 exec, s[70:71], 1
    buffer_load_dwordx4 v[36:39], v229, s[32:35], s63 offen offset:64 sc1
    s_mov_b64 exec, -1
    v_cmp_lt_i32 vcc, 0, v234
    v_cmp_lt_i32 s[70:71], 8, v234
    s_or_b64 exec, vcc, 1
    buffer_load_dwordx4 v[44:47], v230, s[32:35], s64 offen offset:0 sc1
    s_or_b64 exec, s[70:71], 1
    buffer_load_dwordx4 v[48:51], v230, s[32:35], s64 offen offset:64 sc1
    s_mov_b64 exec, -1
    v_cmp_lt_i32 vcc, 0, v235
    v_cmp_lt_i32 s[70:71], 8, v235
    s_or_b64 exec, vcc, 1
    buffer_load_dwordx4 v[56:59], v231, s[32:35], s65 offen offset:0 sc1
    s_or_b64 exec, s[70:71], 1
    buffer_load_dwordx4 v[60:63], v231, s[32:35], s65 offen offset:64 sc1
    s_mov_b64 exec, -1
    s_cmp_lg_u32 s54, 0
    s_cbranch_scc1 K2_R4C
K2_R4B:
    ds_read_b32 v224, v184 offset:42812
    s_waitcnt lgkmcnt(0)
    v_readfirstlane_b32 s62, v224
    s_cmp_lt_u32 s62, 65024
    s_cbranch_scc1 K2_R4B
K2_R4C:
    s_waitcnt vmcnt(6)
K2_EOK:
    v_mov_b32 v225, 1
    s_mov_b64 exec, -1
    v_cmpx_lt_i32 vcc, 0, v232
    v_and_b32 v116, 0xfc, v21
    ds_add_rtn_u32 v84, v116, v225 offset:42496
    v_cmpx_lt_i32 vcc, 1, v232
    v_and_b32 v117, 0xfc, v23
    ds_add_rtn_u32 v85, v117, v225 offset:42496
    v_cmpx_lt_i32 vcc, 8, v232
    s_cbranch_execz K2_R30
    v_and_b32 v118, 0xfc, v25
    ds_add_rtn_u32 v86, v118, v225 offset:42496
    v_cmpx_lt_i32 vcc, 9, v232
    v_and_b32 v119, 0xfc, v27
    ds_add_rtn_u32 v87, v119, v225 offset:42496
    v_cmpx_lt_i32 vcc, 16, v232
    s_cbranch_execz K2_R30
    v_and_b32 v120, 0xfc, v29
    ds_add_rtn_u32 v88, v120, v225 offset:42496
    v_cmpx_lt_i32 vcc, 17, v232
    v_and_b32 v121, 0xfc, v31
    ds_add_rtn_u32 v89, v121, v225 offset:42496
K2_R30:
    s_waitcnt vmcnt(4)
    s_mov_b64 exec, -1
    v_cmpx_lt_i32 vcc, 0, v233
    v_and_b32 v122, 0xfc, v33
    ds_add_rtn_u32 v90, v122, v225 offset:42496
    v_cmpx_lt_i32 vcc, 1, v233
    v_and_b32 v123, 0xfc, v35
    ds_add_rtn_u32 v91, v123, v225 offset:42496
    v_cmpx_lt_i32 vcc, 8, v233
    s_cbranch_execz K2_R31
    v_and_b32 v124, 0xfc, v37
    ds_add_rtn_u32 v92, v124, v225 offset:42496
    v_cmpx_lt_i32 vcc, 9, v233
    v_and_b32 v125, 0xfc, v39
    ds_add_rtn_u32 v93, v125, v225 offset:42496
    v_cmpx_lt_i32 vcc, 16, v233
    s_cbranch_execz K2_R31
    v_and_b32 v126, 0xfc, v41
    ds_add_rtn_u32 v94, v126, v225 offset:42496
    v_cmpx_lt_i32 vcc, 17, v233
    v_and_b32 v127, 0xfc, v43
    ds_add_rtn_u32 v95, v127, v225 offset:42496
K2_R31:
    s_waitcnt vmcnt(2)
    s_mov_b64 exec, -1
    v_cmpx_lt_i32 vcc, 0, v234
    v_and_b32 v128, 0xfc, v45
    ds_add_rtn_u32 v96, v128, v225 offset:42496
    v_cmpx_lt_i32 vcc, 1, v234
    v_and_b32 v129, 0xfc, v47
    ds_add_rtn_u32 v97, v129, v225 offset:42496
    v_cmpx_lt_i32 vcc, 8, v234
    s_cbranch_execz K2_R32
    v_and_b32 v130, 0xfc, v49
    ds_add_rtn_u32 v98, v130, v225 offset:42496
    v_cmpx_lt_i32 vcc, 9, v234
    v_and_b32 v131, 0xfc, v51
    ds_add_rtn_u32 v99, v131, v225 offset:42496
    v_cmpx_lt_i32 vcc, 16, v234
    s_cbranch_execz K2_R32
    v_and_b32 v132, 0xfc, v53
    ds_add_rtn_u32 v100, v132, v225 offset:42496
    v_cmpx_lt_i32 vcc, 17, v234
    v_and_b32 v133, 0xfc, v55
    ds_add_rtn_u32 v101, v133, v225 offset:42496
K2_R32:
    s_waitcnt vmcnt(0)
    s_mov_b64 exec, -1
    v_cmpx_lt_i32 vcc, 0, v235
    v_and_b32 v134, 0xfc, v57
    ds_add_rtn_u32 v102, v134, v225 offset:42496
    v_cmpx_lt_i32 vcc, 1, v235
    v_and_b32 v135, 0xfc, v59
    ds_add_rtn_u32 v103, v135, v225 offset:42496
    v_cmpx_lt_i32 vcc, 8, v235
    s_cbranch_execz K2_R33
    v_and_b32 v136, 0xfc, v61
    ds_add_rtn_u32 v104, v136, v225 offset:42496
    v_cmpx_lt_i32 vcc, 9, v235
    v_and_b32 v137, 0xfc, v63
    ds_add_rtn_u32 v105, v137, v225 offset:42496
    v_cmpx_lt_i32 vcc, 16, v235
    s_cbranch_execz K2_R33
    v_and_b32 v138, 0xfc, v65
    ds_add_rtn_u32 v106, v138, v225 offset:42496
    v_cmpx_lt_i32 vcc, 17, v235
    v_and_b32 v139, 0xfc, v67
    ds_add_rtn_u32 v107, v139, v225 offset:42496
K2_R33:
    s_mov_b64 exec, -1
    ds_add_u32 v18, v222 offset:42816
    s_branch K2_R4
K2_EP:
    v_cmpx_lt_i32 vcc, 16, v232
    s_cbranch_execz K2_EQ0
    buffer_load_dwordx4 v[28:31], v228, s[32:35], s62 offen offset:128 sc1
K2_EQ0:
    s_mov_b64 exec, -1
    v_cmpx_lt_i32 vcc, 16, v233
    s_cbranch_execz K2_EQ1
    buffer_load_dwordx4 v[40:43], v229, s[32:35], s63 offen offset:128 sc1
K2_EQ1:
    s_mov_b64 exec, -1
    v_cmpx_lt_i32 vcc, 16, v234
    s_cbranch_execz K2_EQ2
    buffer_load_dwordx4 v[52:55], v230, s[32:35], s64 offen offset:128 sc1
K2_EQ2:
    s_mov_b64 exec, -1
    v_cmpx_lt_i32 vcc, 16, v235
    s_cbranch_execz K2_EQ3
    buffer_load_dwordx4 v[64:67], v231, s[32:35], s65 offen offset:128 sc1
K2_EQ3:
    s_mov_b64 exec, -1
    s_branch K2_EP1
K2_LONG:
    ds_write_b32 v18, v222 offset:42748
    s_branch K2_EL
K2_LOAD:
    v_and_b32 v224, 31, v1
    v_lshlrev_b32 v225, 2, v224
    v_mul_u32_u24 v226, 928, v2
    s_mov_b32 s62, 114432
    v_add3_u32 v3, v225, v226, s62
    v_mov_b32 v222, 0x3f80
    v_mov_b32 v223, 0
    v_mov_b32 v216, 0x3f003f00
    v_mov_b32 v217, 0
    v_mov_b32 v221, 0x3f80
    v_mov_b32 v14, 0xdddd
    v_mov_b32 v12, 0x4afa0000
    s_mov_b32 s67, 0x44c040c0
    s_mov_b32 s74, 512
    s_mov_b32 s75, 256
    s_mov_b32 s76, -2048
    s_mov_b32 s77, -1025
    s_mov_b32 s68, 0x3f80
    s_mov_b32 s69, 0x3f800000
    v_cvt_f32_u32 v225, v225
    v_mul_f32 v225, 0x00800000, v225
    v_lshrrev_b32 v225, 16, v225
    v_cmp_gt_u32 vcc, 32, v1
    v_mov_b32 v226, 0x8800480
    s_mul_i32 s62, s40, 5248
    s_add_u32 s62, s62, 72448
    s_add_u32 s63, s62, 1024
    v_cndmask_b32 v218, 0, v226, vcc
    v_cndmask_b32 v219, 0, v225, vcc
    v_add_u32 v4, s62, v243
    v_lshl_add_u32 v5, v1, 5, s63
    v_and_b32 v225, 0xf0, v243
    v_add_u32 v225, s62, v225
    v_add_u32 v226, -16, v1
    v_cmp_gt_u32 vcc, 32, v226
    v_mov_b32 v226, 0x80000
    v_bfe_u32 v227, v1, 2, 2
    v_cndmask_b32 v7, v225, v226, vcc
    v_cmp_eq_u32 vcc, 0, v1
    s_lshl_b32 s64, s40, 2
    v_mov_b32 v225, s64
    v_cndmask_b32 v15, v226, v225, vcc
    v_cndmask_b32 v18, v226, v184, vcc
    v_lshl_add_u32 v227, v2, 3, v227
    v_lshlrev_b32 v227, 5, v227
    v_and_b32 v225, 1, v1
    v_lshl_add_u32 v227, v225, 3, v227
    v_and_b32 v226, 16, v1
    v_add_u32 v227, v227, v226
    v_bfe_u32 v224, v1, 1, 1
    v_mul_u32_u24 v224, 2176, v224
    v_add3_u32 v6, v224, v227, s63
    v_lshrrev_b32 v226, 4, v226
    v_lshl_add_u32 v225, v225, 1, v226
    v_mul_u32_u24 v13, 0x5555, v225
    v_bfe_u32 v225, v1, 1, 3
    v_lshlrev_b32 v227, 2, v2
    v_xor_b32 v225, v225, v227
    v_cmp_eq_u32 vcc, 0, v225
    s_nop 1
    v_cndmask_b32 v180, 0, v222, vcc
    v_cmp_eq_u32 vcc, 1, v225
    s_nop 1
    v_cndmask_b32 v181, 0, v222, vcc
    v_cmp_eq_u32 vcc, 2, v225
    s_nop 1
    v_cndmask_b32 v182, 0, v222, vcc
    v_cmp_eq_u32 vcc, 3, v225
    s_nop 1
    v_cndmask_b32 v183, 0, v222, vcc
    s_waitcnt vmcnt(58) lgkmcnt(0)
    s_and_b32 s85, s85, 0xffff0000
    s_mov_b32 s84, 149994
    s_mul_hi_u32 s62, s80, 0x2c9277b5
    s_mul_i32 s63, s81, 0x2c9277b5
    s_add_u32 s63, s63, s62
    s_mul_i32 s62, s80, 0x2c9277b5
    s_add_u32 s80, s62, 0xac564b05
    s_addc_u32 s81, s63, 0x14057b7e
    v_mov_b32 v211, 0
    v_mov_b32 v215, 0
    v_add_u32 v9, 45312, v243
    v_lshl_or_b32 v200, v201, 16, v200
    v_lshl_or_b32 v201, v203, 16, v202
    v_lshl_or_b32 v202, v205, 16, v204
    v_lshl_or_b32 v203, v207, 16, v206
    v_lshlrev_b32 v208, 16, v208
    v_lshlrev_b32 v212, 16, v212
    v_lshlrev_b32 v209, 16, v209
    v_lshlrev_b32 v213, 16, v213
    v_lshlrev_b32 v210, 16, v210
    v_lshlrev_b32 v214, 16, v214
    ds_write_b128 v243, v[208:211] offset:43264
    ds_write_b128 v243, v[212:215] offset:44288
    v_lshlrev_b32 v192, 16, v192
    v_mul_f32 v192, 0x3fb8aa3b, v192
    v_lshlrev_b32 v196, 16, v196
    v_mul_f32 v196, 0x3f31ecbe, v196
    v_lshlrev_b32 v193, 16, v193
    v_mul_f32 v193, 0x3fb8aa3b, v193
    v_lshlrev_b32 v197, 16, v197
    v_mul_f32 v197, 0x3f31ecbe, v197
    v_lshlrev_b32 v194, 16, v194
    v_mul_f32 v194, 0x3fb8aa3b, v194
    v_lshlrev_b32 v198, 16, v198
    v_mul_f32 v198, 0x3f31ecbe, v198
    v_lshlrev_b32 v195, 16, v195
    v_mul_f32 v195, 0x3fb8aa3b, v195
    v_lshlrev_b32 v199, 16, v199
    v_mul_f32 v199, 0x3f31ecbe, v199
    v_cvt_pk_bf16_f32 v188, v192, v193
    v_lshlrev_b32 v224, 16, v188
    v_and_b32 v225, 0xffff0000, v188
    v_sub_f32 v192, v192, v224
    v_sub_f32 v193, v193, v225
    v_cvt_pk_bf16_f32 v189, v192, v193
    v_cvt_pk_bf16_f32 v190, v194, v195
    v_lshlrev_b32 v224, 16, v190
    v_and_b32 v225, 0xffff0000, v190
    v_sub_f32 v194, v194, v224
    v_sub_f32 v195, v195, v225
    v_cvt_pk_bf16_f32 v191, v194, v195
    ds_write_b128 v9, v[188:191]
    ds_write_b128 v9, v[196:199] offset:1024
    s_waitcnt vmcnt(26)
    ds_add_u32 v18, v222 offset:42796
K2_G0:
    s_setprio 0
    s_mov_b32 s36, s4
    s_mov_b32 s37, s5
    s_mov_b32 s38, 0x61a800
    s_mov_b32 s39, 0x20000
    s_mov_b32 s28, s6
    s_mov_b32 s29, s7
    s_mov_b32 s30, 0x249f0
    s_mov_b32 s31, 0x20000
    s_mov_b32 s24, s22
    s_mov_b32 s25, s23
    s_mov_b32 s26, 0xc61a800
    s_mov_b32 s27, 0x20000
    s_lshr_b32 s64, s40, 1
    s_and_b32 s65, s40, 1
    v_bfe_u32 v224, v1, 2, 2
    v_lshl_add_u32 v225, v2, 3, v224
    v_lshlrev_b32 v225, 8, v225
    v_lshl_add_u32 v225, v224, 6, v225
    v_bfe_u32 v224, v1, 4, 1
    v_lshl_add_u32 v225, v224, 5, v225
    v_and_b32 v224, 3, v1
    v_lshl_add_u32 v225, v224, 3, v225
    s_lshl_b32 s65, s65, 7
    v_xor_b32 v228, s65, v225
    v_add_u32 v228, 80128, v228
    v_xor_b32 v229, 64, v228
    s_lshl_b32 s63, s40, 6
    v_xor_b32 v234, s63, v225
    v_add_u32 v240, 47360, v234
K2_G1:
    ds_read_b32 v224, v184 offset:42796
    s_waitcnt lgkmcnt(0)
    v_readfirstlane_b32 s62, v224
    s_cmp_lt_u32 s62, 16256
    s_cbranch_scc1 K2_G1
    ds_read_b64_tr_b16 v[84:85], v228 offset:0
    ds_read_b64_tr_b16 v[86:87], v228 offset:1024
    ds_read_b64_tr_b16 v[88:89], v229 offset:0
    ds_read_b64_tr_b16 v[90:91], v229 offset:1024
    ds_read_b64_tr_b16 v[92:93], v228 offset:4096
    ds_read_b64_tr_b16 v[94:95], v228 offset:5120
    ds_read_b64_tr_b16 v[96:97], v229 offset:4096
    ds_read_b64_tr_b16 v[98:99], v229 offset:5120
    ds_read_b64_tr_b16 v[100:101], v228 offset:8192
    ds_read_b64_tr_b16 v[102:103], v228 offset:9216
    ds_read_b64_tr_b16 v[104:105], v229 offset:8192
    ds_read_b64_tr_b16 v[106:107], v229 offset:9216
    ds_read_b64_tr_b16 v[108:109], v228 offset:12288
    ds_read_b64_tr_b16 v[110:111], v228 offset:13312
    ds_read_b64_tr_b16 v[112:113], v229 offset:12288
    ds_read_b64_tr_b16 v[114:115], v229 offset:13312
    ds_read_b64_tr_b16 v[116:117], v228 offset:16384
    ds_read_b64_tr_b16 v[118:119], v228 offset:17408
    ds_read_b64_tr_b16 v[120:121], v229 offset:16384
    ds_read_b64_tr_b16 v[122:123], v229 offset:17408
    ds_read_b64_tr_b16 v[124:125], v228 offset:20480
    ds_read_b64_tr_b16 v[126:127], v228 offset:21504
    ds_read_b64_tr_b16 v[128:129], v229 offset:20480
    ds_read_b64_tr_b16 v[130:131], v229 offset:21504
    ds_read_b64_tr_b16 v[132:133], v228 offset:24576
    ds_read_b64_tr_b16 v[134:135], v228 offset:25600
    ds_read_b64_tr_b16 v[136:137], v229 offset:24576
    ds_read_b64_tr_b16 v[138:139], v229 offset:25600
    ds_read_b64_tr_b16 v[140:141], v228 offset:28672
    ds_read_b64_tr_b16 v[142:143], v228 offset:29696
    ds_read_b64_tr_b16 v[144:145], v229 offset:28672
    ds_read_b64_tr_b16 v[146:147], v229 offset:29696
    ds_add_u32 v18, v222 offset:42804
    v_and_b32 v225, 31, v1
    v_and_b32 v224, 15, v1
    v_xor_b32 v224, v224, v2
    v_lshlrev_b32 v224, 4, v224
    v_lshl_add_u32 v224, v225, 8, v224
    s_mul_i32 s48, s64, 12288
    s_add_u32 s63, s48, 114432
    v_add_u32 v248, s63, v224
    v_xor_b32 v249, 32, v248
    v_xor_b32 v250, 64, v248
    v_xor_b32 v251, 96, v248
    v_xor_b32 v252, 128, v248
    v_xor_b32 v253, 160, v248
    v_xor_b32 v254, 192, v248
    v_xor_b32 v255, 224, v248
    v_lshlrev_b32 v241, 2, v225
    s_lshl_b32 s63, s40, 13
    s_add_u32 s63, s63, 80128
    v_add_u32 v230, s63, v241
    v_lshl_add_u32 v230, v2, 9, v230
    v_add_u32 v231, 128, v230
    v_add_u32 v232, s63, v243
    v_lshl_add_u32 v241, v2, 10, v241
    s_lshl_b32 s63, s40, 7
    v_add_u32 v241, s63, v241
    v_and_b32 v224, 1, v1
    v_lshlrev_b32 v224, 7, v224
    v_lshl_add_u32 v224, v2, 10, v224
    v_and_b32 v225, 30, v1
    v_lshl_add_u32 v224, v225, 1, v224
    s_lshl_b32 s63, s64, 8
    s_lshr_b32 s62, s65, 1
    s_add_u32 s63, s63, s62
    s_add_u32 s63, s63, 47360
    v_add_u32 v239, s63, v224
    v_lshrrev_b32 v224, 3, v1
    v_lshl_add_u32 v233, v224, 7, v243
    v_lshlrev_b32 v235, 6, v0
    s_lshl_b32 s62, s41, 8
    s_add_u32 s62, s62, s48
    s_add_u32 s62, s62, s65
    s_add_u32 s88, s62, 0xc000000
    s_mov_b32 s66, 0x3fb8aa3b
    s_cmp_lg_u32 s40, 0
    s_cbranch_scc1 K2_G2
    s_waitcnt vmcnt(0)
    ds_add_u32 v18, v222 offset:42800
K2_G2:
    ds_read_b32 v224, v184 offset:42800
    s_waitcnt lgkmcnt(0)
    v_readfirstlane_b32 s62, v224
    s_cmp_lt_u32 s62, 16256
    s_cbranch_scc1 K2_G2
    ds_read_b128 v[148:151], v248 offset:0
    ds_read_b128 v[152:155], v249 offset:0
    ds_read_b128 v[156:159], v250 offset:0
    ds_read_b128 v[160:163], v251 offset:0
    ds_read_b128 v[164:167], v252 offset:0
    ds_read_b128 v[168:171], v253 offset:0
    ds_read_b128 v[172:175], v254 offset:0
    ds_read_b128 v[176:179], v255 offset:0
    s_waitcnt lgkmcnt(7)
    v_mfma_f32_32x32x16_bf16 v[20:35], v[148:151], v[84:87], 0
    v_mfma_f32_32x32x16_bf16 v[36:51], v[148:151], v[88:91], 0
    ds_read_b128 v[148:151], v252 offset:6144
    s_waitcnt lgkmcnt(7)
    v_mfma_f32_32x32x16_bf16 v[20:35], v[152:155], v[92:95], v[20:35]
    v_mfma_f32_32x32x16_bf16 v[36:51], v[152:155], v[96:99], v[36:51]
    ds_read_b128 v[152:155], v253 offset:6144
    s_waitcnt lgkmcnt(7)
    v_mfma_f32_32x32x16_bf16 v[20:35], v[156:159], v[100:103], v[20:35]
    v_mfma_f32_32x32x16_bf16 v[36:51], v[156:159], v[104:107], v[36:51]
    ds_read_b128 v[156:159], v254 offset:6144
    s_waitcnt lgkmcnt(7)
    v_mfma_f32_32x32x16_bf16 v[20:35], v[160:163], v[108:111], v[20:35]
    v_mfma_f32_32x32x16_bf16 v[36:51], v[160:163], v[112:115], v[36:51]
    ds_read_b128 v[160:163], v255 offset:6144
    s_waitcnt lgkmcnt(7)
    v_mfma_f32_32x32x16_bf16 v[20:35], v[164:167], v[116:119], v[20:35]
    v_mfma_f32_32x32x16_bf16 v[36:51], v[164:167], v[120:123], v[36:51]
    ds_read_b128 v[164:167], v248 offset:6144
    s_waitcnt lgkmcnt(7)
    v_mfma_f32_32x32x16_bf16 v[20:35], v[168:171], v[124:127], v[20:35]
    v_mfma_f32_32x32x16_bf16 v[36:51], v[168:171], v[128:131], v[36:51]
    ds_read_b128 v[168:171], v249 offset:6144
    s_waitcnt lgkmcnt(7)
    v_mfma_f32_32x32x16_bf16 v[20:35], v[172:175], v[132:135], v[20:35]
    v_mfma_f32_32x32x16_bf16 v[36:51], v[172:175], v[136:139], v[36:51]
    ds_read_b128 v[172:175], v250 offset:6144
    s_waitcnt lgkmcnt(7)
    v_mfma_f32_32x32x16_bf16 v[20:35], v[176:179], v[140:143], v[20:35]
    v_mfma_f32_32x32x16_bf16 v[36:51], v[176:179], v[144:147], v[36:51]
    ds_read_b128 v[176:179], v251 offset:6144
    s_waitcnt lgkmcnt(7)
    v_mfma_f32_32x32x16_bf16 v[52:67], v[148:151], v[84:87], 0
    v_mfma_f32_32x32x16_bf16 v[68:83], v[148:151], v[88:91], 0
    s_waitcnt lgkmcnt(6)
    v_mfma_f32_32x32x16_bf16 v[52:67], v[152:155], v[92:95], v[52:67]
    v_mfma_f32_32x32x16_bf16 v[68:83], v[152:155], v[96:99], v[68:83]
K2_G3:
    ds_read_b32 v224, v184 offset:42804
    s_waitcnt lgkmcnt(0)
    v_readfirstlane_b32 s62, v224
    s_cmp_lt_u32 s62, 65024
    s_cbranch_scc1 K2_G3
    v_mfma_f32_32x32x16_bf16 v[52:67], v[156:159], v[100:103], v[52:67]
    v_mul_f32 v20, s66, v20
    v_mul_f32 v36, s66, v36
    v_cvt_pk_bf16_f32 v20, v20, v36
    v_mfma_f32_32x32x16_bf16 v[68:83], v[156:159], v[104:107], v[68:83]
    v_mul_f32 v21, s66, v21
    v_mul_f32 v37, s66, v37
    v_cvt_pk_bf16_f32 v21, v21, v37
    v_mfma_f32_32x32x16_bf16 v[52:67], v[160:163], v[108:111], v[52:67]
    v_mul_f32 v22, s66, v22
    v_mul_f32 v38, s66, v38
    v_cvt_pk_bf16_f32 v22, v22, v38
    v_mfma_f32_32x32x16_bf16 v[68:83], v[160:163], v[112:115], v[68:83]
    v_mul_f32 v23, s66, v23
    v_mul_f32 v39, s66, v39
    v_cvt_pk_bf16_f32 v23, v23, v39
    ds_write2st64_b32 v230, v20, v22 offset0:0 offset1:1
    ds_write2st64_b32 v231, v21, v23 offset0:0 offset1:1
    ds_read_b128 v[148:151], v232 offset:0
    v_mfma_f32_32x32x16_bf16 v[52:67], v[164:167], v[116:119], v[52:67]
    v_mul_f32 v24, s66, v24
    v_mul_f32 v40, s66, v40
    v_cvt_pk_bf16_f32 v24, v24, v40
    v_mfma_f32_32x32x16_bf16 v[68:83], v[164:167], v[120:123], v[68:83]
    v_mul_f32 v25, s66, v25
    v_mul_f32 v41, s66, v41
    v_cvt_pk_bf16_f32 v25, v25, v41
    v_mfma_f32_32x32x16_bf16 v[52:67], v[168:171], v[124:127], v[52:67]
    v_mul_f32 v26, s66, v26
    v_mul_f32 v42, s66, v42
    v_cvt_pk_bf16_f32 v26, v26, v42
    v_mfma_f32_32x32x16_bf16 v[68:83], v[168:171], v[128:131], v[68:83]
    v_mul_f32 v27, s66, v27
    v_mul_f32 v43, s66, v43
    v_cvt_pk_bf16_f32 v27, v27, v43
    s_waitcnt lgkmcnt(0)
    s_add_u32 s63, s88, 0
    buffer_store_dwordx4 v[148:151], v233, s[24:27], s63 offen sc1
    ds_write2st64_b32 v230, v24, v26 offset0:4 offset1:5
    ds_write2st64_b32 v231, v25, v27 offset0:4 offset1:5
    ds_read_b128 v[152:155], v232 offset:1024
    v_mfma_f32_32x32x16_bf16 v[52:67], v[172:175], v[132:135], v[52:67]
    v_mul_f32 v28, s66, v28
    v_mul_f32 v44, s66, v44
    v_cvt_pk_bf16_f32 v28, v28, v44
    v_mfma_f32_32x32x16_bf16 v[68:83], v[172:175], v[136:139], v[68:83]
    v_mul_f32 v29, s66, v29
    v_mul_f32 v45, s66, v45
    v_cvt_pk_bf16_f32 v29, v29, v45
    v_mfma_f32_32x32x16_bf16 v[52:67], v[176:179], v[140:143], v[52:67]
    v_mul_f32 v30, s66, v30
    v_mul_f32 v46, s66, v46
    v_cvt_pk_bf16_f32 v30, v30, v46
    v_mfma_f32_32x32x16_bf16 v[68:83], v[176:179], v[144:147], v[68:83]
    v_mul_f32 v31, s66, v31
    v_mul_f32 v47, s66, v47
    v_cvt_pk_bf16_f32 v31, v31, v47
    s_waitcnt lgkmcnt(0)
    s_add_u32 s63, s88, 2048
    buffer_store_dwordx4 v[152:155], v233, s[24:27], s63 offen sc1
    ds_write2st64_b32 v230, v28, v30 offset0:8 offset1:9
    ds_write2st64_b32 v231, v29, v31 offset0:8 offset1:9
    ds_read_b128 v[156:159], v232 offset:2048
    v_subrev_u32 v248, s48, v248
    v_subrev_u32 v249, s48, v249
    v_subrev_u32 v250, s48, v250
    v_subrev_u32 v251, s48, v251
    v_subrev_u32 v252, s48, v252
    v_subrev_u32 v253, s48, v253
    v_subrev_u32 v254, s48, v254
    v_subrev_u32 v255, s48, v255
    v_mul_f32 v52, s66, v52
    v_mul_f32 v53, s66, v53
    v_mul_f32 v54, s66, v54
    v_mul_f32 v55, s66, v55
    v_mul_f32 v68, s66, v68
    v_mul_f32 v69, s66, v69
    v_mul_f32 v70, s66, v70
    v_mul_f32 v71, s66, v71
    v_cvt_pk_bf16_f32 v52, v52, v68
    v_cvt_pk_bf16_f32 v53, v53, v69
    v_cvt_pk_bf16_f32 v54, v54, v70
    v_cvt_pk_bf16_f32 v55, v55, v71
    ds_write2st64_b32 v230, v52, v54 offset0:16 offset1:17
    ds_write2st64_b32 v231, v53, v55 offset0:16 offset1:17
    ds_read_b128 v[160:163], v232 offset:4096
    s_waitcnt lgkmcnt(3)
    s_add_u32 s63, s88, 4096
    buffer_store_dwordx4 v[156:159], v233, s[24:27], s63 offen sc1
    v_mul_f32 v56, s66, v56
    v_mul_f32 v57, s66, v57
    v_mul_f32 v58, s66, v58
    v_mul_f32 v59, s66, v59
    v_mul_f32 v72, s66, v72
    v_mul_f32 v73, s66, v73
    v_mul_f32 v74, s66, v74
    v_mul_f32 v75, s66, v75
    v_cvt_pk_bf16_f32 v56, v56, v72
    v_cvt_pk_bf16_f32 v57, v57, v73
    v_cvt_pk_bf16_f32 v58, v58, v74
    v_cvt_pk_bf16_f32 v59, v59, v75
    ds_write2st64_b32 v230, v56, v58 offset0:20 offset1:21
    ds_write2st64_b32 v231, v57, v59 offset0:20 offset1:21
    ds_read_b128 v[164:167], v232 offset:5120
    v_mul_f32 v60, s66, v60
    v_mul_f32 v61, s66, v61
    v_mul_f32 v62, s66, v62
    v_mul_f32 v63, s66, v63
    v_mul_f32 v76, s66, v76
    v_mul_f32 v77, s66, v77
    v_mul_f32 v78, s66, v78
    v_mul_f32 v79, s66, v79
    v_cvt_pk_bf16_f32 v60, v60, v76
    v_cvt_pk_bf16_f32 v61, v61, v77
    v_cvt_pk_bf16_f32 v62, v62, v78
    v_cvt_pk_bf16_f32 v63, v63, v79
    ds_write2st64_b32 v230, v60, v62 offset0:24 offset1:25
    ds_write2st64_b32 v231, v61, v63 offset0:24 offset1:25
    ds_read_b128 v[168:171], v232 offset:6144
    v_mul_f32 v64, s66, v64
    v_mul_f32 v65, s66, v65
    v_mul_f32 v80, s66, v80
    v_mul_f32 v81, s66, v81
    v_cvt_pk_bf16_f32 v64, v64, v80
    v_cvt_pk_bf16_f32 v65, v65, v81
    ds_write_b32 v230, v64 offset:7168
    ds_write_b32 v230, v65 offset:7296
    ds_read_b128 v[172:175], v232 offset:7168
    s_waitcnt lgkmcnt(9)
    s_add_u32 s63, s88, 6144
    buffer_store_dwordx4 v[160:163], v233, s[24:27], s63 offen sc1
    s_waitcnt lgkmcnt(6)
    s_add_u32 s63, s88, 8192
    buffer_store_dwordx4 v[164:167], v233, s[24:27], s63 offen sc1
    ds_add_u32 v18, v222 offset:42828
    s_waitcnt lgkmcnt(3)
    s_add_u32 s63, s88, 10240
    buffer_store_dwordx4 v[168:171], v233, s[24:27], s63 offen sc1
    s_mov_b64 exec, 0xffff
    s_waitcnt lgkmcnt(0)
    s_add_u32 s63, s88, 12288
    buffer_store_dwordx4 v[172:175], v233, s[24:27], s63 offen sc1
    s_mov_b64 exec, -1
    s_cmp_lg_u32 s40, 0
    s_cbranch_scc1 K2_G33
    buffer_store_dwordx4 v[200:203], v243, s[32:35], s46 offen sc1
    s_lshl_b32 s66, s41, 4
    s_add_u32 s66, s66, 0xc000000
    s_lshr_b32 s66, s2, 3
    s_mul_i32 s66, s66, 4736
    v_lshlrev_b32 v226, 7, v1
    s_mov_b32 exec_hi, 31
    buffer_load_dword v226, v226, s[28:31], s66 offen
    s_mov_b64 exec, -1
K2_G33:
K2_G31:
    ds_read_b32 v224, v184 offset:42808
    s_waitcnt lgkmcnt(0)
    v_readfirstlane_b32 s62, v224
    s_cmp_lt_u32 s62, 65024
    s_cbranch_scc1 K2_G31
    ds_read_b64_tr_b16 v[84:85], v234 offset:0
    ds_read_b64_tr_b16 v[86:87], v234 offset:1024
    ds_read_b64_tr_b16 v[88:89], v234 offset:4096
    ds_read_b64_tr_b16 v[90:91], v234 offset:5120
    ds_read_b64_tr_b16 v[92:93], v234 offset:8192
    ds_read_b64_tr_b16 v[94:95], v234 offset:9216
    ds_read_b64_tr_b16 v[96:97], v234 offset:12288
    ds_read_b64_tr_b16 v[98:99], v234 offset:13312
    ds_read_b64_tr_b16 v[100:101], v234 offset:16384
    ds_read_b64_tr_b16 v[102:103], v234 offset:17408
    ds_read_b64_tr_b16 v[104:105], v234 offset:20480
    ds_read_b64_tr_b16 v[106:107], v234 offset:21504
    ds_read_b64_tr_b16 v[108:109], v234 offset:24576
    ds_read_b64_tr_b16 v[110:111], v234 offset:25600
    ds_read_b64_tr_b16 v[112:113], v234 offset:28672
    ds_read_b64_tr_b16 v[114:115], v234 offset:29696
    ds_read_b64_tr_b16 v[116:117], v240 offset:0
    ds_read_b64_tr_b16 v[118:119], v240 offset:1024
    ds_read_b64_tr_b16 v[120:121], v240 offset:4096
    ds_read_b64_tr_b16 v[122:123], v240 offset:5120
    ds_read_b64_tr_b16 v[124:125], v240 offset:8192
    ds_read_b64_tr_b16 v[126:127], v240 offset:9216
    ds_read_b64_tr_b16 v[128:129], v240 offset:12288
    ds_read_b64_tr_b16 v[130:131], v240 offset:13312
    ds_read_b64_tr_b16 v[132:133], v240 offset:16384
    ds_read_b64_tr_b16 v[134:135], v240 offset:17408
    ds_read_b64_tr_b16 v[136:137], v240 offset:20480
    ds_read_b64_tr_b16 v[138:139], v240 offset:21504
    ds_read_b64_tr_b16 v[140:141], v240 offset:24576
    ds_read_b64_tr_b16 v[142:143], v240 offset:25600
    ds_read_b64_tr_b16 v[144:145], v240 offset:28672
    ds_read_b64_tr_b16 v[146:147], v240 offset:29696
    ds_add_u32 v18, v222 offset:42812
    s_mov_b32 s66, 0x3fb8aa3b
    s_mov_b32 s65, 0x3fb82aef
    ds_read_b128 v[148:151], v248 offset:0
    ds_read_b128 v[152:155], v249 offset:0
    ds_read_b128 v[156:159], v250 offset:0
    ds_read_b128 v[160:163], v251 offset:0
    ds_read_b128 v[164:167], v252 offset:0
    ds_read_b128 v[168:171], v253 offset:0
    ds_read_b128 v[172:175], v254 offset:0
    ds_read_b128 v[176:179], v255 offset:0
    s_waitcnt lgkmcnt(6)
    v_mfma_f32_32x32x16_bf16 v[20:35], v[148:151], v[84:87], 0
    ds_read_b128 v[148:151], v252 offset:6144
    v_mfma_f32_32x32x16_bf16 v[20:35], v[152:155], v[88:91], v[20:35]
    ds_read_b128 v[152:155], v253 offset:6144
    s_waitcnt lgkmcnt(6)
    v_mfma_f32_32x32x16_bf16 v[20:35], v[156:159], v[92:95], v[20:35]
    ds_read_b128 v[156:159], v254 offset:6144
    v_mfma_f32_32x32x16_bf16 v[20:35], v[160:163], v[96:99], v[20:35]
    ds_read_b128 v[160:163], v255 offset:6144
    s_waitcnt lgkmcnt(6)
    v_mfma_f32_32x32x16_bf16 v[20:35], v[164:167], v[100:103], v[20:35]
    ds_read_b128 v[164:167], v248 offset:6144
    v_mfma_f32_32x32x16_bf16 v[20:35], v[168:171], v[104:107], v[20:35]
    ds_read_b128 v[168:171], v249 offset:6144
    s_waitcnt lgkmcnt(6)
    v_mfma_f32_32x32x16_bf16 v[20:35], v[172:175], v[108:111], v[20:35]
    ds_read_b128 v[172:175], v250 offset:6144
    v_mfma_f32_32x32x16_bf16 v[20:35], v[176:179], v[112:115], v[20:35]
    ds_read_b128 v[176:179], v251 offset:6144
    s_waitcnt lgkmcnt(6)
    v_mfma_f32_32x32x16_bf16 v[36:51], v[148:151], v[84:87], 0
    ds_read_b128 v[148:151], v248 offset:12288
    s_nop 4
    v_mfma_f32_32x32x16_bf16 v[36:51], v[152:155], v[88:91], v[36:51]
    ds_read_b128 v[152:155], v249 offset:12288
K2_G4:
    ds_read_b32 v224, v184 offset:42812
    s_waitcnt lgkmcnt(0)
    v_readfirstlane_b32 s62, v224
    s_cmp_lt_u32 s62, 65024
    s_cbranch_scc1 K2_G4
    s_waitcnt lgkmcnt(6)
    v_mfma_f32_32x32x16_bf16 v[36:51], v[156:159], v[92:95], v[36:51]
    ds_read_b128 v[156:159], v250 offset:12288
    v_mul_f32 v20, s66, v20
    v_mul_f32 v21, s66, v21
    v_cvt_pk_bf16_f32 v20, v20, v21
    v_mfma_f32_32x32x16_bf16 v[36:51], v[160:163], v[96:99], v[36:51]
    ds_read_b128 v[160:163], v251 offset:12288
    v_mul_f32 v22, s66, v22
    v_mul_f32 v23, s66, v23
    v_cvt_pk_bf16_f32 v22, v22, v23
    s_waitcnt lgkmcnt(6)
    v_mfma_f32_32x32x16_bf16 v[36:51], v[164:167], v[100:103], v[36:51]
    ds_read_b128 v[164:167], v252 offset:12288
    ds_write2st64_b32 v241, v20, v22 offset0:0 offset1:2
    v_mul_f32 v24, s66, v24
    v_mul_f32 v25, s66, v25
    v_cvt_pk_bf16_f32 v24, v24, v25
    v_mfma_f32_32x32x16_bf16 v[36:51], v[168:171], v[104:107], v[36:51]
    ds_read_b128 v[168:171], v253 offset:12288
    v_mul_f32 v26, s66, v26
    v_mul_f32 v27, s66, v27
    v_cvt_pk_bf16_f32 v26, v26, v27
    s_waitcnt lgkmcnt(7)
    v_mfma_f32_32x32x16_bf16 v[36:51], v[172:175], v[108:111], v[36:51]
    ds_read_b128 v[172:175], v254 offset:12288
    ds_write2st64_b32 v241, v24, v26 offset0:8 offset1:10
    v_mul_f32 v28, s66, v28
    v_mul_f32 v29, s66, v29
    v_cvt_pk_bf16_f32 v28, v28, v29
    v_mfma_f32_32x32x16_bf16 v[36:51], v[176:179], v[112:115], v[36:51]
    ds_read_b128 v[176:179], v255 offset:12288
    s_waitcnt vmcnt(0)
    s_mov_b64 exec, 1
    ds_add_rtn_u32 v224, v184, v222 offset:42820
    s_waitcnt lgkmcnt(0)
    v_readfirstlane_b32 s62, v224
    s_mov_b64 exec, -1
    s_cmp_lg_u32 s62, 48768
    s_cbranch_scc1 K2_G5
    v_mul_u32_u24 v226, 33024, v1
    v_mov_b32 v224, s80
    v_mov_b32 v225, s81
    s_lshl_b32 s62, s3, 6
    s_add_u32 s62, s62, 0xd510000
    s_mov_b64 exec, 0xff
    buffer_store_dwordx2 v[224:225], v226, s[32:35], s62 offen sc1
    s_mov_b64 exec, -1
K2_G5:
    v_mul_f32 v30, s66, v30
    v_mul_f32 v31, s66, v31
    v_cvt_pk_bf16_f32 v30, v30, v31
    s_waitcnt lgkmcnt(6)
    v_mfma_f32_32x32x16_bf16 v[52:67], v[148:151], v[84:87], 0
    ds_read_b128 v[148:151], v252 offset:18432
    ds_write2st64_b32 v241, v28, v30 offset0:16 offset1:18
    v_mfma_f32_32x32x16_bf16 v[52:67], v[152:155], v[88:91], v[52:67]
    ds_read_b128 v[152:155], v253 offset:18432
    s_waitcnt lgkmcnt(7)
    v_mfma_f32_32x32x16_bf16 v[52:67], v[156:159], v[92:95], v[52:67]
    ds_read_b128 v[156:159], v254 offset:18432
    v_mul_f32 v36, s66, v36
    v_mul_f32 v37, s66, v37
    v_cvt_pk_bf16_f32 v36, v36, v37
    v_mfma_f32_32x32x16_bf16 v[52:67], v[160:163], v[96:99], v[52:67]
    ds_read_b128 v[160:163], v255 offset:18432
    v_mul_f32 v38, s66, v38
    v_mul_f32 v39, s66, v39
    v_cvt_pk_bf16_f32 v38, v38, v39
    s_waitcnt lgkmcnt(7)
    v_mfma_f32_32x32x16_bf16 v[52:67], v[164:167], v[100:103], v[52:67]
    ds_read_b128 v[164:167], v248 offset:18432
    ds_write2st64_b32 v241, v36, v38 offset0:24 offset1:26
    v_mul_f32 v40, s66, v40
    v_mul_f32 v41, s66, v41
    v_cvt_pk_bf16_f32 v40, v40, v41
    v_mfma_f32_32x32x16_bf16 v[52:67], v[168:171], v[104:107], v[52:67]
    ds_read_b128 v[168:171], v249 offset:18432
    v_mul_f32 v42, s66, v42
    v_mul_f32 v43, s66, v43
    v_cvt_pk_bf16_f32 v42, v42, v43
    s_waitcnt lgkmcnt(8)
    v_mfma_f32_32x32x16_bf16 v[52:67], v[172:175], v[108:111], v[52:67]
    ds_read_b128 v[172:175], v250 offset:18432
    ds_write2st64_b32 v241, v40, v42 offset0:32 offset1:34
    v_mul_f32 v44, s66, v44
    v_mul_f32 v45, s66, v45
    v_cvt_pk_bf16_f32 v44, v44, v45
    v_mfma_f32_32x32x16_bf16 v[52:67], v[176:179], v[112:115], v[52:67]
    ds_read_b128 v[176:179], v251 offset:18432
    v_mul_f32 v46, s66, v46
    v_mul_f32 v47, s66, v47
    v_cvt_pk_bf16_f32 v46, v46, v47
    s_waitcnt lgkmcnt(8)
    v_mfma_f32_32x32x16_bf16 v[68:83], v[148:151], v[84:87], 0
    ds_read_b128 v[148:151], v248 offset:0
    ds_write2st64_b32 v241, v44, v46 offset0:40 offset1:42
    v_mfma_f32_32x32x16_bf16 v[68:83], v[152:155], v[88:91], v[68:83]
    ds_read_b128 v[152:155], v249 offset:0
    s_waitcnt lgkmcnt(9)
    v_mfma_f32_32x32x16_bf16 v[68:83], v[156:159], v[92:95], v[68:83]
    ds_read_b128 v[156:159], v250 offset:0
    v_mul_f32 v52, s66, v52
    v_mul_f32 v53, s66, v53
    v_cvt_pk_bf16_f32 v52, v52, v53
    v_mfma_f32_32x32x16_bf16 v[68:83], v[160:163], v[96:99], v[68:83]
    ds_read_b128 v[160:163], v251 offset:0
    v_mul_f32 v54, s66, v54
    v_mul_f32 v55, s66, v55
    v_cvt_pk_bf16_f32 v54, v54, v55
    s_waitcnt lgkmcnt(8)
    v_mfma_f32_32x32x16_bf16 v[68:83], v[164:167], v[100:103], v[68:83]
    ds_read_b128 v[164:167], v252 offset:0
    ds_write2st64_b32 v241, v52, v54 offset0:48 offset1:50
    v_mul_f32 v56, s66, v56
    v_mul_f32 v57, s66, v57
    v_cvt_pk_bf16_f32 v56, v56, v57
    v_mfma_f32_32x32x16_bf16 v[68:83], v[168:171], v[104:107], v[68:83]
    ds_read_b128 v[168:171], v253 offset:0
    v_mul_f32 v58, s66, v58
    v_mul_f32 v59, s66, v59
    v_cvt_pk_bf16_f32 v58, v58, v59
    s_waitcnt lgkmcnt(8)
    v_mfma_f32_32x32x16_bf16 v[68:83], v[172:175], v[108:111], v[68:83]
    ds_read_b128 v[172:175], v254 offset:0
    ds_write2st64_b32 v241, v56, v58 offset0:56 offset1:58
    v_mul_f32 v60, s66, v60
    v_mul_f32 v61, s66, v61
    v_cvt_pk_bf16_f32 v60, v60, v61
    v_mfma_f32_32x32x16_bf16 v[68:83], v[176:179], v[112:115], v[68:83]
    ds_read_b128 v[176:179], v255 offset:0
    v_mul_f32 v62, s66, v62
    v_mul_f32 v63, s66, v63
    v_cvt_pk_bf16_f32 v62, v62, v63
    s_waitcnt lgkmcnt(8)
    v_mfma_f32_32x32x16_bf16 v[20:35], v[148:151], v[116:119], 0
    ds_read_b128 v[148:151], v252 offset:6144
    ds_write2st64_b32 v241, v60, v62 offset0:64 offset1:66
    v_mfma_f32_32x32x16_bf16 v[20:35], v[152:155], v[120:123], v[20:35]
    ds_read_b128 v[152:155], v253 offset:6144
    s_waitcnt lgkmcnt(9)
    v_mfma_f32_32x32x16_bf16 v[20:35], v[156:159], v[124:127], v[20:35]
    ds_read_b128 v[156:159], v254 offset:6144
    v_mul_f32 v68, s66, v68
    v_mul_f32 v69, s66, v69
    v_cvt_pk_bf16_f32 v68, v68, v69
    v_mfma_f32_32x32x16_bf16 v[20:35], v[160:163], v[128:131], v[20:35]
    ds_read_b128 v[160:163], v255 offset:6144
    v_mul_f32 v70, s66, v70
    v_mul_f32 v71, s66, v71
    v_cvt_pk_bf16_f32 v70, v70, v71
    s_waitcnt lgkmcnt(8)
    v_mfma_f32_32x32x16_bf16 v[20:35], v[164:167], v[132:135], v[20:35]
    ds_read_b128 v[164:167], v248 offset:6144
    ds_write2st64_b32 v241, v68, v70 offset0:72 offset1:74
    v_mul_f32 v72, s66, v72
    v_mul_f32 v73, s66, v73
    v_cvt_pk_bf16_f32 v72, v72, v73
    v_mfma_f32_32x32x16_bf16 v[20:35], v[168:171], v[136:139], v[20:35]
    ds_read_b128 v[168:171], v249 offset:6144
    v_mul_f32 v74, s66, v74
    v_mul_f32 v75, s66, v75
    v_cvt_pk_bf16_f32 v74, v74, v75
    s_waitcnt lgkmcnt(8)
    v_mfma_f32_32x32x16_bf16 v[20:35], v[172:175], v[140:143], v[20:35]
    ds_read_b128 v[172:175], v250 offset:6144
    ds_write2st64_b32 v241, v72, v74 offset0:80 offset1:82
    v_mul_f32 v76, s66, v76
    v_mul_f32 v77, s66, v77
    v_cvt_pk_bf16_f32 v76, v76, v77
    v_mfma_f32_32x32x16_bf16 v[20:35], v[176:179], v[144:147], v[20:35]
    ds_read_b128 v[176:179], v251 offset:6144
    v_mul_f32 v78, s66, v78
    v_mul_f32 v79, s66, v79
    v_cvt_pk_bf16_f32 v78, v78, v79
    s_waitcnt lgkmcnt(8)
    v_mfma_f32_32x32x16_bf16 v[36:51], v[148:151], v[116:119], 0
    ds_read_b128 v[148:151], v248 offset:12288
    ds_write2st64_b32 v241, v76, v78 offset0:88 offset1:90
    v_mul_f32 v80, s66, v80
    v_mul_f32 v81, s66, v81
    v_cvt_pk_bf16_f32 v80, v80, v81
    v_mfma_f32_32x32x16_bf16 v[36:51], v[152:155], v[120:123], v[36:51]
    ds_read_b128 v[152:155], v249 offset:12288
    s_mov_b32 exec_hi, 0
    ds_write_b32 v241, v80 offset:24576
    s_mov_b64 exec, -1
    s_waitcnt lgkmcnt(10)
    v_mfma_f32_32x32x16_bf16 v[36:51], v[156:159], v[124:127], v[36:51]
    ds_read_b128 v[156:159], v250 offset:12288
    v_mul_f32 v20, s65, v20
    v_mul_f32 v21, s65, v21
    v_cvt_pk_bf16_f32 v20, v20, v21
    v_mfma_f32_32x32x16_bf16 v[36:51], v[160:163], v[128:131], v[36:51]
    ds_read_b128 v[160:163], v251 offset:12288
    v_mul_f32 v22, s65, v22
    v_mul_f32 v23, s65, v23
    v_cvt_pk_bf16_f32 v22, v22, v23
    s_waitcnt lgkmcnt(9)
    v_mfma_f32_32x32x16_bf16 v[36:51], v[164:167], v[132:135], v[36:51]
    ds_read_b128 v[164:167], v252 offset:12288
    ds_write2st64_b32 v239, v20, v22 offset0:0 offset1:2
    v_mul_f32 v24, s65, v24
    v_mul_f32 v25, s65, v25
    v_cvt_pk_bf16_f32 v24, v24, v25
    v_mfma_f32_32x32x16_bf16 v[36:51], v[168:171], v[136:139], v[36:51]
    ds_read_b128 v[168:171], v253 offset:12288
    v_mul_f32 v26, s65, v26
    v_mul_f32 v27, s65, v27
    v_cvt_pk_bf16_f32 v26, v26, v27
    s_waitcnt lgkmcnt(9)
    v_mfma_f32_32x32x16_bf16 v[36:51], v[172:175], v[140:143], v[36:51]
    ds_read_b128 v[172:175], v254 offset:12288
    ds_write2st64_b32 v239, v24, v26 offset0:8 offset1:10
    v_mul_f32 v28, s65, v28
    v_mul_f32 v29, s65, v29
    v_cvt_pk_bf16_f32 v28, v28, v29
    v_mfma_f32_32x32x16_bf16 v[36:51], v[176:179], v[144:147], v[36:51]
    ds_read_b128 v[176:179], v255 offset:12288
    v_mul_f32 v30, s65, v30
    v_mul_f32 v31, s65, v31
    v_cvt_pk_bf16_f32 v30, v30, v31
    s_waitcnt lgkmcnt(9)
    v_mfma_f32_32x32x16_bf16 v[52:67], v[148:151], v[116:119], 0
    ds_read_b128 v[148:151], v252 offset:18432
    ds_write2st64_b32 v239, v28, v30 offset0:16 offset1:18
    v_mfma_f32_32x32x16_bf16 v[52:67], v[152:155], v[120:123], v[52:67]
    ds_read_b128 v[152:155], v253 offset:18432
    s_waitcnt lgkmcnt(9)
    v_mfma_f32_32x32x16_bf16 v[52:67], v[156:159], v[124:127], v[52:67]
    ds_read_b128 v[156:159], v254 offset:18432
    v_mul_f32 v36, s65, v36
    v_mul_f32 v37, s65, v37
    v_cvt_pk_bf16_f32 v36, v36, v37
    v_mfma_f32_32x32x16_bf16 v[52:67], v[160:163], v[128:131], v[52:67]
    ds_read_b128 v[160:163], v255 offset:18432
    v_mul_f32 v38, s65, v38
    v_mul_f32 v39, s65, v39
    v_cvt_pk_bf16_f32 v38, v38, v39
    s_waitcnt lgkmcnt(8)
    v_mfma_f32_32x32x16_bf16 v[52:67], v[164:167], v[132:135], v[52:67]
    ds_read_b128 v[164:167], v248 offset:18432
    ds_write2st64_b32 v239, v36, v38 offset0:24 offset1:26
    v_mul_f32 v40, s65, v40
    v_mul_f32 v41, s65, v41
    v_cvt_pk_bf16_f32 v40, v40, v41
    v_mfma_f32_32x32x16_bf16 v[52:67], v[168:171], v[136:139], v[52:67]
    ds_read_b128 v[168:171], v249 offset:18432
    v_mul_f32 v42, s65, v42
    v_mul_f32 v43, s65, v43
    v_cvt_pk_bf16_f32 v42, v42, v43
    s_waitcnt lgkmcnt(8)
    v_mfma_f32_32x32x16_bf16 v[52:67], v[172:175], v[140:143], v[52:67]
    ds_read_b128 v[172:175], v250 offset:18432
    ds_write2st64_b32 v239, v40, v42 offset0:32 offset1:34
    v_mul_f32 v44, s65, v44
    v_mul_f32 v45, s65, v45
    v_cvt_pk_bf16_f32 v44, v44, v45
    v_mfma_f32_32x32x16_bf16 v[52:67], v[176:179], v[144:147], v[52:67]
    ds_read_b128 v[176:179], v251 offset:18432
    v_mul_f32 v46, s65, v46
    v_mul_f32 v47, s65, v47
    v_cvt_pk_bf16_f32 v46, v46, v47
    s_waitcnt lgkmcnt(8)
    v_mfma_f32_32x32x16_bf16 v[68:83], v[148:151], v[116:119], 0
    ds_write2st64_b32 v239, v44, v46 offset0:40 offset1:42
    s_nop 1
    v_mfma_f32_32x32x16_bf16 v[68:83], v[152:155], v[120:123], v[68:83]
    s_waitcnt lgkmcnt(7)
    v_mfma_f32_32x32x16_bf16 v[68:83], v[156:159], v[124:127], v[68:83]
    v_mul_f32 v52, s65, v52
    v_mul_f32 v53, s65, v53
    v_cvt_pk_bf16_f32 v52, v52, v53
    v_mfma_f32_32x32x16_bf16 v[68:83], v[160:163], v[128:131], v[68:83]
    v_mul_f32 v54, s65, v54
    v_mul_f32 v55, s65, v55
    v_cvt_pk_bf16_f32 v54, v54, v55
    s_waitcnt lgkmcnt(4)
    v_mfma_f32_32x32x16_bf16 v[68:83], v[164:167], v[132:135], v[68:83]
    ds_write2st64_b32 v239, v52, v54 offset0:48 offset1:50
    v_mul_f32 v56, s65, v56
    v_mul_f32 v57, s65, v57
    v_cvt_pk_bf16_f32 v56, v56, v57
    v_mfma_f32_32x32x16_bf16 v[68:83], v[168:171], v[136:139], v[68:83]
    v_mul_f32 v58, s65, v58
    v_mul_f32 v59, s65, v59
    v_cvt_pk_bf16_f32 v58, v58, v59
    s_waitcnt lgkmcnt(2)
    v_mfma_f32_32x32x16_bf16 v[68:83], v[172:175], v[140:143], v[68:83]
    ds_write2st64_b32 v239, v56, v58 offset0:56 offset1:58
    v_mul_f32 v60, s65, v60
    v_mul_f32 v61, s65, v61
    v_cvt_pk_bf16_f32 v60, v60, v61
    v_mfma_f32_32x32x16_bf16 v[68:83], v[176:179], v[144:147], v[68:83]
    v_mul_f32 v62, s65, v62
    v_mul_f32 v63, s65, v63
    v_cvt_pk_bf16_f32 v62, v62, v63
    ds_write2st64_b32 v239, v60, v62 offset0:64 offset1:66
    s_nop 7
    v_mul_f32 v68, s65, v68
    v_mul_f32 v69, s65, v69
    v_cvt_pk_bf16_f32 v68, v68, v69
    v_mul_f32 v70, s65, v70
    v_mul_f32 v71, s65, v71
    v_cvt_pk_bf16_f32 v70, v70, v71
    ds_write2st64_b32 v239, v68, v70 offset0:72 offset1:74
    v_mul_f32 v72, s65, v72
    v_mul_f32 v73, s65, v73
    v_cvt_pk_bf16_f32 v72, v72, v73
    v_mul_f32 v74, s65, v74
    v_mul_f32 v75, s65, v75
    v_cvt_pk_bf16_f32 v74, v74, v75
    ds_write2st64_b32 v239, v72, v74 offset0:80 offset1:82
    v_mul_f32 v76, s65, v76
    v_mul_f32 v77, s65, v77
    v_cvt_pk_bf16_f32 v76, v76, v77
    v_mul_f32 v78, s65, v78
    v_mul_f32 v79, s65, v79
    v_cvt_pk_bf16_f32 v78, v78, v79
    ds_write2st64_b32 v239, v76, v78 offset0:88 offset1:90
    v_mul_f32 v80, s65, v80
    v_mul_f32 v81, s65, v81
    v_cvt_pk_bf16_f32 v80, v80, v81
    s_mov_b32 exec_hi, 0
    ds_write_b32 v239, v80 offset:24576
    s_mov_b64 exec, -1
    s_mov_b32 s61, 0
K2_GR:
    s_cmp_lg_u32 s56, 0
    s_cbranch_scc1 K2_R4
    v_lshlrev_b32 v211, 2, v1
K2_G6:
    ds_read_b32 v224, v184 offset:42816
    ds_read_b32 v212, v211 offset:42496
    s_waitcnt lgkmcnt(0)
    v_readfirstlane_b32 s62, v224
    s_cmp_lt_u32 s62, 65024
    s_cbranch_scc1 K2_G6
    s_and_b32 s59, s2, 7
    s_mul_i32 s59, s59, 33024
    s_add_u32 s59, s59, 0xd510000
    buffer_load_dwordx2 v[230:231], v235, s[32:35], s59 offen sc1
    s_branch K2_R41
K2_R4:
    v_lshlrev_b32 v211, 2, v1
K2_R40:
    ds_read_b32 v224, v184 offset:42816
    ds_read_b32 v212, v211 offset:42496
    s_waitcnt lgkmcnt(0)
    v_readfirstlane_b32 s62, v224
    s_cmp_lt_u32 s62, 65024
    s_cbranch_scc1 K2_R40
K2_R41:
    s_mov_b32 s72, -1
    s_mov_b32 s73, 0x1ffff
    s_waitcnt lgkmcnt(0)
    v_readlane_b32 s44, v212, 63
    v_max_u32 v213, 16, v212
    v_cndmask_b32 v213, 0, v213, s[72:73]
    v_mov_b32 v214, v213
    s_nop 1
    v_add_u32_dpp v214, v214, v214 row_shr:1 row_mask:0xf bank_mask:0xf
    s_nop 1
    v_add_u32_dpp v214, v214, v214 row_shr:2 row_mask:0xf bank_mask:0xf
    s_nop 1
    v_add_u32_dpp v214, v214, v214 row_shr:4 row_mask:0xf bank_mask:0xf
    s_nop 1
    v_add_u32_dpp v214, v214, v214 row_shr:8 row_mask:0xf bank_mask:0xf
    s_nop 1
    v_add_u32_dpp v214, v214, v214 row_bcast:15 row_mask:0xa bank_mask:0xf
    s_nop 1
    v_add_u32_dpp v214, v214, v214 row_bcast:31 row_mask:0xc bank_mask:0xf
    s_nop 1
    v_readlane_b32 s45, v214, 63
    v_sub_u32 v214, v214, v213
    v_lshlrev_b32 v214, 2, v214
    s_cmp_gt_u32 s45, 2048
    s_cbranch_scc1 K2_RETRY
    s_add_u32 s46, s45, 15
    s_lshr_b32 s46, s46, 4
    s_cmp_lt_u32 s40, 4
    s_cbranch_scc1 K2_G9
    ds_write_b32 v211, v214 offset:43008
    v_max3_i32 v224, v232, v233, v234
    v_max_i32 v224, v224, v235
    v_cmp_lt_i32 vcc, 16, v224
    ds_read_b32 v148, v116 offset:43008
    ds_read_b32 v149, v117 offset:43008
    ds_read_b32 v150, v118 offset:43008
    ds_read_b32 v151, v119 offset:43008
    ds_read_b32 v154, v122 offset:43008
    ds_read_b32 v155, v123 offset:43008
    ds_read_b32 v156, v124 offset:43008
    ds_read_b32 v157, v125 offset:43008
    ds_read_b32 v160, v128 offset:43008
    ds_read_b32 v161, v129 offset:43008
    ds_read_b32 v162, v130 offset:43008
    ds_read_b32 v163, v131 offset:43008
    ds_read_b32 v166, v134 offset:43008
    ds_read_b32 v167, v135 offset:43008
    ds_read_b32 v168, v136 offset:43008
    ds_read_b32 v169, v137 offset:43008
    s_cbranch_vccz K2_R5
    ds_read_b32 v152, v120 offset:43008
    ds_read_b32 v153, v121 offset:43008
    ds_read_b32 v158, v126 offset:43008
    ds_read_b32 v159, v127 offset:43008
    ds_read_b32 v164, v132 offset:43008
    ds_read_b32 v165, v133 offset:43008
    ds_read_b32 v170, v138 offset:43008
    ds_read_b32 v171, v139 offset:43008
K2_R5:
    v_mov_b32 v226, 0x437f0000
    s_cmp_lt_u32 s40, 6
    s_cbranch_scc1 K2_R6
    s_cmp_eq_u32 s40, 6
    s_cbranch_scc1 K2_R5B
    v_add_lshl_u32 v224, v1, s45, 2
    v_mov_b32 v225, 192
    ds_write2st64_b32 v224, v226, v225 offset0:98 offset1:132
    ds_write2st64_b32 v224, v226, v225 offset0:99 offset1:133
    s_branch K2_R6
K2_R5B:
    v_lshl_add_u32 v224, v212, 2, v214
    s_mov_b64 exec, s[72:73]
K2_R5C:
    v_cmpx_gt_u32 vcc, 16, v212
    s_cbranch_execz K2_R6
    ds_write2st64_b32 v224, v226, v211 offset0:98 offset1:132
    v_add_u32 v224, 4, v224
    v_add_u32 v212, 1, v212
    s_branch K2_R5C
K2_R6:
    s_setprio 2
    s_mov_b64 exec, -1
    s_lshr_b32 s62, s46, 2
    s_and_b32 s63, s46, 3
    s_lshr_b32 s64, s46, 3
    s_add_u32 s64, s64, 1
    s_and_b32 s65, s62, 1
    s_mov_b32 s48, 0
    s_cmp_lt_u32 s40, 4
    s_cbranch_scc1 K2_R8
    s_mul_i32 s48, s63, s65
    s_lshl2_add_u32 s48, s64, s48
    s_sub_u32 s64, s62, s64
    s_xor_b32 s65, s65, 1
K2_R8:
    s_and_b32 s62, s40, 3
    s_mul_i32 s66, s62, s64
    s_add_u32 s48, s48, s66
    s_min_u32 s66, s62, s63
    s_mul_i32 s66, s66, s65
    s_add_u32 s48, s48, s66
    s_cmp_lt_u32 s62, s63
    s_cselect_b32 s65, s65, 0
    s_add_u32 s47, s64, s65
    s_waitcnt lgkmcnt(0)
    s_mov_b64 exec, -1
    v_cmpx_lt_i32 vcc, 0, v232
    v_lshl_add_u32 v148, v84, 2, v148
    ds_write2st64_b32 v148, v20, v21 offset0:98 offset1:132
    v_cmpx_lt_i32 vcc, 1, v232
    v_lshl_add_u32 v149, v85, 2, v149
    ds_write2st64_b32 v149, v22, v23 offset0:98 offset1:132
    v_cmpx_lt_i32 vcc, 8, v232
    s_cbranch_execz K2_R60
    v_lshl_add_u32 v150, v86, 2, v150
    ds_write2st64_b32 v150, v24, v25 offset0:98 offset1:132
    v_cmpx_lt_i32 vcc, 9, v232
    v_lshl_add_u32 v151, v87, 2, v151
    ds_write2st64_b32 v151, v26, v27 offset0:98 offset1:132
    v_cmpx_lt_i32 vcc, 16, v232
    s_cbranch_execz K2_R60
    v_lshl_add_u32 v152, v88, 2, v152
    ds_write2st64_b32 v152, v28, v29 offset0:98 offset1:132
    v_cmpx_lt_i32 vcc, 17, v232
    v_lshl_add_u32 v153, v89, 2, v153
    ds_write2st64_b32 v153, v30, v31 offset0:98 offset1:132
K2_R60:
    s_mov_b64 exec, -1
    v_cmpx_lt_i32 vcc, 0, v233
    v_lshl_add_u32 v154, v90, 2, v154
    ds_write2st64_b32 v154, v32, v33 offset0:98 offset1:132
    v_cmpx_lt_i32 vcc, 1, v233
    v_lshl_add_u32 v155, v91, 2, v155
    ds_write2st64_b32 v155, v34, v35 offset0:98 offset1:132
    v_cmpx_lt_i32 vcc, 8, v233
    s_cbranch_execz K2_R61
    v_lshl_add_u32 v156, v92, 2, v156
    ds_write2st64_b32 v156, v36, v37 offset0:98 offset1:132
    v_cmpx_lt_i32 vcc, 9, v233
    v_lshl_add_u32 v157, v93, 2, v157
    ds_write2st64_b32 v157, v38, v39 offset0:98 offset1:132
    v_cmpx_lt_i32 vcc, 16, v233
    s_cbranch_execz K2_R61
    v_lshl_add_u32 v158, v94, 2, v158
    ds_write2st64_b32 v158, v40, v41 offset0:98 offset1:132
    v_cmpx_lt_i32 vcc, 17, v233
    v_lshl_add_u32 v159, v95, 2, v159
    ds_write2st64_b32 v159, v42, v43 offset0:98 offset1:132
K2_R61:
    s_mov_b64 exec, -1
    v_cmpx_lt_i32 vcc, 0, v234
    v_lshl_add_u32 v160, v96, 2, v160
    ds_write2st64_b32 v160, v44, v45 offset0:98 offset1:132
    v_cmpx_lt_i32 vcc, 1, v234
    v_lshl_add_u32 v161, v97, 2, v161
    ds_write2st64_b32 v161, v46, v47 offset0:98 offset1:132
    v_cmpx_lt_i32 vcc, 8, v234
    s_cbranch_execz K2_R62
    v_lshl_add_u32 v162, v98, 2, v162
    ds_write2st64_b32 v162, v48, v49 offset0:98 offset1:132
    v_cmpx_lt_i32 vcc, 9, v234
    v_lshl_add_u32 v163, v99, 2, v163
    ds_write2st64_b32 v163, v50, v51 offset0:98 offset1:132
    v_cmpx_lt_i32 vcc, 16, v234
    s_cbranch_execz K2_R62
    v_lshl_add_u32 v164, v100, 2, v164
    ds_write2st64_b32 v164, v52, v53 offset0:98 offset1:132
    v_cmpx_lt_i32 vcc, 17, v234
    v_lshl_add_u32 v165, v101, 2, v165
    ds_write2st64_b32 v165, v54, v55 offset0:98 offset1:132
K2_R62:
    s_mov_b64 exec, -1
    v_cmpx_lt_i32 vcc, 0, v235
    v_lshl_add_u32 v166, v102, 2, v166
    ds_write2st64_b32 v166, v56, v57 offset0:98 offset1:132
    v_cmpx_lt_i32 vcc, 1, v235
    v_lshl_add_u32 v167, v103, 2, v167
    ds_write2st64_b32 v167, v58, v59 offset0:98 offset1:132
    v_cmpx_lt_i32 vcc, 8, v235
    s_cbranch_execz K2_R63
    v_lshl_add_u32 v168, v104, 2, v168
    ds_write2st64_b32 v168, v60, v61 offset0:98 offset1:132
    v_cmpx_lt_i32 vcc, 9, v235
    v_lshl_add_u32 v169, v105, 2, v169
    ds_write2st64_b32 v169, v62, v63 offset0:98 offset1:132
    v_cmpx_lt_i32 vcc, 16, v235
    s_cbranch_execz K2_R63
    v_lshl_add_u32 v170, v106, 2, v170
    ds_write2st64_b32 v170, v64, v65 offset0:98 offset1:132
    v_cmpx_lt_i32 vcc, 17, v235
    v_lshl_add_u32 v171, v107, 2, v171
    ds_write2st64_b32 v171, v66, v67 offset0:98 offset1:132
K2_R63:
    s_mov_b64 exec, -1
K2_R7:
    s_mov_b64 exec, -1
    v_add_lshl_u32 v224, v1, s48, 6
    v_add_u32 v224, 33792, v224
    s_lshl_b32 m0, s48, 6
    s_waitcnt lgkmcnt(0)
    s_barrier
    s_setprio 1
    ds_read_addtid_b32 v220 offset:25088
    ds_read_addtid_b32 v9 offset:33792
    s_sub_u32 s66, s47, 1
    s_waitcnt lgkmcnt(1)
    v_mfma_f32_32x32x8_bf16 v[148:163], v[220:221], v[218:219], 0
    v_dot2_f32_bf16 v225, v220, s67, v12
    v_cmp_gt_u32 vcc, 0x437f0000, v220
    s_waitcnt lgkmcnt(0)
    v_lshlrev_b32_sdwa v11, 3, v9 dst_sel:DWORD dst_unused:UNUSED_PAD src0_sel:DWORD src1_sel:BYTE_0
    v_and_b32 v225, 0x7fffff, v225
    buffer_load_dwordx2 v[208:209], v225, s[28:31], 0 offen
    v_cmp_eq_u32 s[82:83], s84, v225
    v_mov_b32 v10, v9
    s_mov_b64 s[70:71], vcc
    ds_read_addtid_b32 v220 offset:25152
    s_mov_b64 exec, 0x3ffff
    ds_read_b32 v232, v224
    ds_read2_b32 v[234:235], v224 offset0:15 offset1:16
    s_mov_b64 exec, -1
    buffer_load_dword v164, v148, s[24:27], 0 offen offset:0 sc1
    buffer_load_dword v165, v149, s[24:27], 0 offen offset:0 sc1
    buffer_load_dword v166, v150, s[24:27], 0 offen offset:0 sc1
    buffer_load_dword v167, v151, s[24:27], 0 offen offset:0 sc1
    buffer_load_dword v168, v152, s[24:27], 0 offen offset:0 sc1
    buffer_load_dword v169, v153, s[24:27], 0 offen offset:0 sc1
    buffer_load_dword v170, v154, s[24:27], 0 offen offset:0 sc1
    buffer_load_dword v171, v155, s[24:27], 0 offen offset:0 sc1
    ds_read_b96 v[212:214], v11 offset:43264
    ds_read_addtid_b32 v8 offset:25344
    ds_read_addtid_b32 v9 offset:34048
    buffer_load_dword v172, v148, s[24:27], 0 offen offset:128 sc1
    buffer_load_dword v173, v149, s[24:27], 0 offen offset:128 sc1
    buffer_load_dword v174, v150, s[24:27], 0 offen offset:128 sc1
    buffer_load_dword v175, v151, s[24:27], 0 offen offset:128 sc1
    buffer_load_dword v176, v152, s[24:27], 0 offen offset:128 sc1
    buffer_load_dword v177, v153, s[24:27], 0 offen offset:128 sc1
    buffer_load_dword v178, v154, s[24:27], 0 offen offset:128 sc1
    buffer_load_dword v179, v155, s[24:27], 0 offen offset:128 sc1
    s_waitcnt lgkmcnt(0)
    v_mfma_f32_32x32x8_bf16 v[148:163], v[220:221], v[218:219], 0
    v_and_b32 v232, 0xfc, v232
    v_and_b32 v235, 0xfc, v235
    v_readfirstlane_b32 s50, v232
    v_readlane_b32 s57, v234, s66
    v_readlane_b32 s58, v235, s66
    v_cmp_ne_u32 vcc, v232, v235
    v_mfma_f32_32x32x8_bf16 v[20:35], v[184:185], v[184:185], 0
    v_mfma_f32_32x32x8_bf16 v[36:51], v[184:185], v[184:185], 0
    v_mfma_f32_32x32x8_bf16 v[52:67], v[184:185], v[184:185], 0
    v_mfma_f32_32x32x8_bf16 v[68:83], v[184:185], v[184:185], 0
    v_mfma_f32_32x32x8_bf16 v[132:147], v[184:185], v[184:185], 0
    s_lshl_b32 s51, vcc_lo, 1
    s_lshr_b32 s50, s50, 2
    s_add_u32 s62, s50, 1
    s_and_b32 s62, s62, -2
    s_lshl_b32 m0, s62, 9
    s_or_b32 s62, s50, 1
    ds_read_addtid_b32 v188 offset:0
    ds_read_addtid_b32 v192 offset:256
    s_lshl_b32 m0, s62, 9
    s_bfe_u32 s57, s57, 0x50003
    ds_read_addtid_b32 v189 offset:0
    ds_read_addtid_b32 v193 offset:256
    s_lshr_b32 s58, s58, 3
    s_cmp_eq_u32 s58, s57
    s_cselect_b32 s58, 1, 0
    s_cmp_eq_u32 s40, 7
    s_cselect_b32 s58, 0, s58
    s_mov_b32 s55, 0
    s_mov_b32 s49, 0
    s_mov_b32 s52, -1
    s_mov_b32 s54, 0
    s_bfm_b32 s62, s47, 0
    s_and_b32 s51, s51, s62
    s_and_b32 s60, s62, 0x11110
    s_lshl_b32 s61, 3, s66
    s_bitset1_b32 s61, 2
    s_or_b32 s59, s51, s60
    s_or_b32 s59, s59, s61
    s_lshl_b32 s62, s48, 6
    s_add_u32 m0, s62, 64
    v_lshlrev_b32 v224, 4, v1
    v_add_u32 v224, 45312, v224
    ds_read_b64 v[190:191], v224
    ds_read_b64 v[194:195], v224 offset:8
    ds_read_b128 v[196:199], v224 offset:1024
    v_mov_b32 v204, 0
    v_mov_b32 v205, 0
    v_mov_b32 v206, 0
    v_mov_b32 v207, 0
    v_mov_b32 v16, v6
    v_add_u32 v17, 256, v7
    ds_write_b128 v4, v[184:187] offset:1024
    ds_write_b128 v4, v[184:187] offset:2048
    ds_write_b128 v4, v[184:187] offset:3200
    ds_write_b128 v4, v[184:187] offset:4224
    s_lshr_b32 s86, s40, 1
    s_xor_b32 s86, s86, 2
    s_and_b32 s65, s40, 1
    s_mul_i32 s66, s86, 24
    s_add_u32 s62, s66, s41
    s_lshl1_add_u32 s62, s62, s65
    s_lshl_b32 s87, s62, 7
    s_add_u32 s88, s87, 4096
    v_and_b32 v227, 31, v1
    v_lshlrev_b32 v246, 2, v227
    s_lshl_b32 s62, s40, 12
    v_add_u32 v242, s62, v246
    v_lshl_add_u32 v242, v2, 9, v242
    v_lshl_add_u32 v243, v1, 4, s62
    v_lshl_add_u32 v246, v2, 10, v246
    v_lshrrev_b32 v224, 3, v1
    v_lshlrev_b32 v225, 4, v1
    v_lshl_add_u32 v245, v224, 7, v225
    s_mul_i32 s62, s65, 20992
    s_add_u32 s62, s62, 72448
    v_add_u32 v238, s62, v225
    s_add_u32 s62, s66, s65
    s_lshl_b32 s62, s62, 8
    s_add_u32 s62, s62, 47360
    v_add_u32 v236, s62, v246
    v_add_u32 v224, s66, v227
    v_min_u32 v224, 97, v224
    v_lshrrev_b32 v225, 1, v224
    v_and_b32 v224, 1, v224
    v_mul_u32_u24 v225, 928, v225
    v_mul_u32_u24 v224, 272, v224
    v_lshlrev_b32 v239, 4, v2
    v_add_u32 v239, 114432, v239
    v_add3_u32 v237, v224, v225, v239
    s_lshl_b32 s62, s40, 5
    v_add_u32 v224, s62, v227
    v_mul_u32_u24 v225, 171, v224
    v_lshrrev_b32 v225, 9, v225
    v_cmp_gt_u32 vcc, 147, v224
    v_mad_i32_i24 v224, v225, -3, v224
    s_mov_b32 s78, vcc_lo
    s_mov_b32 s79, 0
    v_mul_u32_u24 v226, 928, v225
    v_lshl_add_u32 v226, v224, 7, v226
    v_add_u32 v239, v239, v226
    v_lshlrev_b32 v241, 5, v225
    v_lshl_add_u32 v241, v224, 2, v241
    v_add_u32 v241, 43264, v241
    v_mul_u32_u24 v240, 12, v225
    v_lshl_add_u32 v240, v224, 1, v240
    v_lshlrev_b32 v224, 4, v227
    v_cmp_gt_u32 vcc, 2, v227
    v_lshlrev_b32 v224, v224, v222
    v_and_b32 v247, 3, v1
    v_cndmask_b32 v252, 0, v224, vcc
    v_cndmask_b32 v253, 0, v224, vcc
    v_cndmask_b32 v254, 0, v224, vcc
    v_cndmask_b32 v255, 0, v224, vcc
    v_mul_u32_u24 v247, 0x5555, v247
    v_bfe_u32 v224, v1, 2, 3
    v_lshlrev_b32 v225, 2, v2
    v_xor_b32 v224, v224, v225
    v_cmp_eq_u32 vcc, 0, v224
    s_nop 1
    v_cndmask_b32 v248, 0, v222, vcc
    v_cmp_eq_u32 vcc, 2, v224
    s_nop 1
    v_cndmask_b32 v249, 0, v222, vcc
    v_cmp_eq_u32 vcc, 1, v224
    s_nop 1
    v_cndmask_b32 v250, 0, v222, vcc
    v_cmp_eq_u32 vcc, 3, v224
    s_nop 1
    v_cndmask_b32 v251, 0, v222, vcc
K2_S1:
    s_waitcnt vmcnt(16)
    v_lshlrev_b32 v210, 16, v209
    s_mov_b64 exec, s[82:83]
    v_mov_b32 v210, s85
    s_mov_b64 exec, -1
    v_and_b32 v209, 0xffff0000, v208
    v_lshlrev_b32 v208, 16, v208
    v_sub_f32 v212, v212, v208
    v_sub_f32 v213, v213, v209
    v_sub_f32 v214, v214, v210
    v_cvt_pk_bf16_f32 v224, v212, v213
    v_cvt_pk_bf16_f32 v225, v214, 0
    v_add_u32_sdwa v227, v5, v10 dst_sel:DWORD dst_unused:UNUSED_PAD src0_sel:DWORD src1_sel:BYTE_1
    v_dot2_f32_bf16 v226, v225, v225, 0
    v_dot2_f32_bf16 v226, v224, v224, v226
    v_lshlrev_b64 v[228:229], v11, v[222:223]
    v_and_b32 v19, -8, v227
    s_mov_b64 exec, s[70:71]
    ds_write_b16 v227, v222
    ds_write_b16 v227, v224 offset:4
    ds_write_b16_d16_hi v227, v224 offset:2176
    ds_write_b16 v227, v225 offset:2180
    s_mov_b64 exec, -1
    v_cvt_pk_bf16_f32 v230, v226, v10
    v_cvt_pk_bf16_f32 v231, v226, v10
    ds_write_b128 v4, v[228:231]
    ds_read_b128 v[200:203], v7
    s_waitcnt lgkmcnt(0)
    v_mfma_f32_32x32x16_bf16 v[84:99], v[200:203], v[188:191], 0
    s_waitcnt vmcnt(8)
    v_smfmac_f32_32x32x32_bf16 v[84:99], v[180:183], v[164:171], v13
    buffer_load_dword v164, v148, s[24:27], 0 offen offset:0 sc1
    buffer_load_dword v165, v149, s[24:27], 0 offen offset:0 sc1
    buffer_load_dword v166, v150, s[24:27], 0 offen offset:0 sc1
    buffer_load_dword v167, v151, s[24:27], 0 offen offset:0 sc1
    buffer_load_dword v168, v152, s[24:27], 0 offen offset:0 sc1
    buffer_load_dword v169, v153, s[24:27], 0 offen offset:0 sc1
    buffer_load_dword v170, v154, s[24:27], 0 offen offset:0 sc1
    buffer_load_dword v171, v155, s[24:27], 0 offen offset:0 sc1
    s_nop 1
    s_branch K2_ENTRY
.p2align 6
K2_LOOP:
    v_mfma_f32_32x32x16_bf16 v[84:99], v[200:203], v[188:191], 0
    v_rcp_f32 v132, v132
    v_rcp_f32 v133, v133
    v_rcp_f32 v134, v134
    v_rcp_f32 v135, v135
    s_waitcnt vmcnt(8)
    v_smfmac_f32_32x32x32_bf16 v[84:99], v[180:183], v[164:171], v13
    buffer_load_dword v164, v148, s[24:27], 0 offen offset:0 sc1
    buffer_load_dword v165, v149, s[24:27], 0 offen offset:0 sc1
    buffer_load_dword v166, v150, s[24:27], 0 offen offset:0 sc1
    buffer_load_dword v167, v151, s[24:27], 0 offen offset:0 sc1
    v_rcp_f32 v136, v136
    v_rcp_f32 v137, v137
    v_rcp_f32 v138, v138
    v_rcp_f32 v139, v139
    v_smfmac_f32_32x32x32_bf16 v[20:35], v[204:207], v[116:123], v14
    buffer_load_dword v168, v152, s[24:27], 0 offen offset:0 sc1
    buffer_load_dword v169, v153, s[24:27], 0 offen offset:0 sc1
    buffer_load_dword v170, v154, s[24:27], 0 offen offset:0 sc1
    buffer_load_dword v171, v155, s[24:27], 0 offen offset:0 sc1
    v_rcp_f32 v140, v140
    v_rcp_f32 v141, v141
    v_rcp_f32 v142, v142
    v_rcp_f32 v143, v143
    v_smfmac_f32_32x32x32_bf16 v[36:51], v[204:207], v[124:131], v14
    s_setprio 1
    v_rcp_f32 v144, v144
    v_rcp_f32 v145, v145
    v_rcp_f32 v146, v146
    v_rcp_f32 v147, v147
    v_pk_mul_f32 v[132:133], v[132:133], v[100:101]
    v_pk_mul_f32 v[134:135], v[134:135], v[102:103]
    v_pk_mul_f32 v[136:137], v[136:137], v[104:105]
    v_pk_mul_f32 v[138:139], v[138:139], v[106:107]
    v_pk_mul_f32 v[140:141], v[140:141], v[108:109]
    v_pk_mul_f32 v[142:143], v[142:143], v[110:111]
    v_pk_mul_f32 v[144:145], v[144:145], v[112:113]
    v_pk_mul_f32 v[146:147], v[146:147], v[114:115]
K2_ENTRY:
    v_mfma_f32_32x32x16_bf16 v[100:115], v[200:203], v[192:195], 0
    s_add_u32 s49, s49, 1
    s_add_u32 m0, m0, 64
    v_exp_f32 v116, -v84
    v_exp_f32 v117, -v85
    v_exp_f32 v118, -v86
    v_exp_f32 v119, -v87
    s_waitcnt vmcnt(8)
    v_smfmac_f32_32x32x32_bf16 v[100:115], v[180:183], v[172:179], v13
    buffer_load_dword v172, v148, s[24:27], 0 offen offset:128 sc1
    buffer_load_dword v173, v149, s[24:27], 0 offen offset:128 sc1
    buffer_load_dword v174, v150, s[24:27], 0 offen offset:128 sc1
    buffer_load_dword v175, v151, s[24:27], 0 offen offset:128 sc1
    v_exp_f32 v120, -v88
    v_exp_f32 v121, -v89
    v_exp_f32 v122, -v90
    v_exp_f32 v123, -v91
    v_smfmac_f32_32x32x32_bf16 v[52:67], v[204:207], v[132:139], v14
    buffer_load_dword v176, v152, s[24:27], 0 offen offset:128 sc1
    buffer_load_dword v177, v153, s[24:27], 0 offen offset:128 sc1
    buffer_load_dword v178, v154, s[24:27], 0 offen offset:128 sc1
    buffer_load_dword v179, v155, s[24:27], 0 offen offset:128 sc1
    v_exp_f32 v124, -v92
    v_exp_f32 v125, -v93
    v_exp_f32 v126, -v94
    v_exp_f32 v127, -v95
    v_smfmac_f32_32x32x32_bf16 v[68:83], v[204:207], v[140:147], v14
    ds_read_b64_tr_b16 v[204:205], v16
    ds_read_b64_tr_b16 v[206:207], v16 offset:128
    s_bitcmp1_b32 s59, s49
    v_exp_f32 v128, -v96
    v_exp_f32 v129, -v97
    v_exp_f32 v130, -v98
    v_exp_f32 v131, -v99
    v_exp_f32 v132, -v100
    v_exp_f32 v133, -v101
    s_cbranch_scc1 K2_EVENT
K2_L2:
    v_mfma_f32_32x32x8_bf16 v[116:131], v[216:217], v[216:217], v[116:131]
    ds_read_addtid_b32 v220 offset:25088
    ds_read_b128 v[200:203], v17
    s_setprio 0
    v_exp_f32 v134, -v102
    v_exp_f32 v135, -v103
    v_exp_f32 v136, -v104
    v_exp_f32 v137, -v105
    v_exp_f32 v138, -v106
    v_exp_f32 v139, -v107
    v_exp_f32 v140, -v108
    v_exp_f32 v141, -v109
    v_exp_f32 v142, -v110
    v_exp_f32 v143, -v111
    v_exp_f32 v144, -v112
    v_exp_f32 v145, -v113
    v_exp_f32 v146, -v114
    v_exp_f32 v147, -v115
    v_rcp_f32 v116, v116
    v_rcp_f32 v117, v117
    v_mfma_f32_32x32x8_bf16 v[132:147], v[216:217], v[216:217], v[132:147]
    s_setprio 2
    v_lshl_add_u64 v[16:17], v[16:17], 0, s[74:75]
    v_rcp_f32 v118, v118
    v_rcp_f32 v119, v119
    v_rcp_f32 v120, v120
    v_rcp_f32 v121, v121
    s_waitcnt lgkmcnt(0)
    v_mfma_f32_32x32x8_bf16 v[148:163], v[220:221], v[218:219], 0
    s_cmp_lt_u32 s49, s47
    v_rcp_f32 v122, v122
    v_rcp_f32 v123, v123
    v_rcp_f32 v124, v124
    v_rcp_f32 v125, v125
    v_rcp_f32 v126, v126
    v_rcp_f32 v127, v127
    v_rcp_f32 v128, v128
    v_rcp_f32 v129, v129
    v_rcp_f32 v130, v130
    v_rcp_f32 v131, v131
    v_pk_mul_f32 v[116:117], v[116:117], v[84:85]
    v_pk_mul_f32 v[118:119], v[118:119], v[86:87]
    v_pk_mul_f32 v[120:121], v[120:121], v[88:89]
    v_pk_mul_f32 v[122:123], v[122:123], v[90:91]
    v_pk_mul_f32 v[124:125], v[124:125], v[92:93]
    v_pk_mul_f32 v[126:127], v[126:127], v[94:95]
    v_pk_mul_f32 v[128:129], v[128:129], v[96:97]
    v_pk_mul_f32 v[130:131], v[130:131], v[98:99]
    s_cbranch_scc1 K2_LOOP
    s_waitcnt vmcnt(16)
    ds_add_u32 v18, v222 offset:42832
    ds_read_b32 v224, v15 offset:42756
    s_mul_i32 s62, s57, 1856
    v_rcp_f32 v132, v132
    v_rcp_f32 v133, v133
    v_smfmac_f32_32x32x32_bf16 v[20:35], v[204:207], v[116:123], v14
    v_add_u32 v244, s62, v3
    v_rcp_f32 v134, v134
    v_rcp_f32 v135, v135
    v_rcp_f32 v136, v136
    v_rcp_f32 v137, v137
    v_rcp_f32 v138, v138
    v_smfmac_f32_32x32x32_bf16 v[36:51], v[204:207], v[124:131], v14
    s_cmp_eq_u32 s58, 0
    v_rcp_f32 v139, v139
    v_rcp_f32 v140, v140
    v_rcp_f32 v141, v141
    v_rcp_f32 v142, v142
    v_rcp_f32 v143, v143
    v_rcp_f32 v144, v144
    v_rcp_f32 v145, v145
    v_rcp_f32 v146, v146
    v_rcp_f32 v147, v147
    s_cbranch_scc1 K2_D3
K2_D2:
    s_waitcnt lgkmcnt(0)
    v_readfirstlane_b32 s62, v224
    ds_read_b32 v224, v15 offset:42756
    s_cmp_eq_u32 s62, 0
    s_cbranch_scc1 K2_D2
    ds_read2_b32 v[208:209], v244 offset0:0 offset1:32
    ds_read2_b32 v[210:211], v244 offset0:68 offset1:100
    ds_read2_b32 v[212:213], v244 offset0:132 offset1:164
    ds_read_b32 v214, v244 offset:784
K2_D3:
    v_pk_mul_f32 v[132:133], v[132:133], v[100:101]
    v_pk_mul_f32 v[134:135], v[134:135], v[102:103]
    v_pk_mul_f32 v[136:137], v[136:137], v[104:105]
    v_pk_mul_f32 v[138:139], v[138:139], v[106:107]
    v_pk_mul_f32 v[140:141], v[140:141], v[108:109]
    v_pk_mul_f32 v[142:143], v[142:143], v[110:111]
    v_pk_mul_f32 v[144:145], v[144:145], v[112:113]
    v_pk_mul_f32 v[146:147], v[146:147], v[114:115]
    s_lshr_b32 s53, s50, 1
    v_smfmac_f32_32x32x32_bf16 v[52:67], v[204:207], v[132:139], v14
    v_smfmac_f32_32x32x32_bf16 v[68:83], v[204:207], v[140:147], v14
    s_waitcnt lgkmcnt(0)
    s_mov_b32 s54, 1
    s_nop 4
    s_cmp_lt_u32 s53, s57
    s_cbranch_scc1 K2_FLUSH
K2_D1:
    s_mov_b32 s53, s57
    s_mov_b32 s54, 2
    s_mov_b32 s55, s58
    s_branch K2_FLUSH
K2_EVENT:
    s_setprio 3
    s_cmp_lg_u32 s49, s52
    s_cbranch_scc1 K2_E1
K2_FLUSH:
    s_mul_i32 s62, s53, 1856
    v_add_u32 v244, s62, v3
    s_bitcmp1_b32 s53, 0
    s_cbranch_scc1 K2_FLP1
K2_FLP0:
    s_cmp_lg_u32 s55, 0
    v_pk_mul_f32 v[224:225], v[22:23], v[196:197] op_sel_hi:[1,0]
    v_pk_mul_f32 v[226:227], v[24:25], v[196:197] op_sel_hi:[1,0]
    v_pk_mul_f32 v[228:229], v[26:27], v[196:197] op_sel_hi:[1,0]
    v_pk_fma_f32 v[224:225], v[38:39], v[196:197], v[224:225] op_sel:[0,1,0] op_sel_hi:[1,1,1]
    v_pk_fma_f32 v[226:227], v[40:41], v[196:197], v[226:227] op_sel:[0,1,0] op_sel_hi:[1,1,1]
    v_pk_fma_f32 v[228:229], v[42:43], v[196:197], v[228:229] op_sel:[0,1,0] op_sel_hi:[1,1,1]
    v_pk_fma_f32 v[224:225], v[54:55], v[198:199], v[224:225] op_sel:[0,0,0] op_sel_hi:[1,0,1]
    v_pk_fma_f32 v[226:227], v[56:57], v[198:199], v[226:227] op_sel:[0,0,0] op_sel_hi:[1,0,1]
    v_pk_fma_f32 v[228:229], v[58:59], v[198:199], v[228:229] op_sel:[0,0,0] op_sel_hi:[1,0,1]
    v_pk_fma_f32 v[224:225], v[70:71], v[198:199], v[224:225] op_sel:[0,1,0] op_sel_hi:[1,1,1]
    v_pk_fma_f32 v[226:227], v[72:73], v[198:199], v[226:227] op_sel:[0,1,0] op_sel_hi:[1,1,1]
    v_pk_fma_f32 v[228:229], v[74:75], v[198:199], v[228:229] op_sel:[0,1,0] op_sel_hi:[1,1,1]
    s_cbranch_scc1 K2_FLM0
K2_FLN0:
    v_mfma_f32_4x4x4_16b_bf16 v[24:27], v[184:185], v[184:185], 0
    v_cvt_pk_bf16_f32 v230, v20, v36
    v_cvt_pk_bf16_f32 v232, v21, v37
    v_mfma_f32_4x4x4_16b_bf16 v[40:43], v[184:185], v[184:185], 0
    ds_write2_b32 v244, v230, v232 offset0:0 offset1:68
    v_mfma_f32_4x4x4_16b_bf16 v[56:59], v[184:185], v[184:185], 0
    v_cvt_pk_bf16_f32 v231, v52, v68
    v_cvt_pk_bf16_f32 v233, v53, v69
    v_mfma_f32_4x4x4_16b_bf16 v[72:75], v[184:185], v[184:185], 0
    ds_write2_b32 v244, v231, v233 offset0:32 offset1:100
    v_cvt_pk_bf16_f32 v224, v224, v225
    v_mfma_f32_4x4x4_16b_bf16 v[20:23], v[184:185], v[184:185], 0
    v_cvt_pk_bf16_f32 v226, v226, v227
    v_mfma_f32_4x4x4_16b_bf16 v[36:39], v[184:185], v[184:185], 0
    ds_write2_b32 v244, v224, v226 offset0:132 offset1:164
    v_cvt_pk_bf16_f32 v228, v228, v229
    v_mfma_f32_4x4x4_16b_bf16 v[52:55], v[184:185], v[184:185], 0
    ds_write_b32 v244, v228 offset:784
    ds_write_b32 v15, v222 offset:42752
    s_cmp_lg_u32 s54, 0
    v_mfma_f32_4x4x4_16b_bf16 v[68:71], v[184:185], v[184:185], 0
    s_cbranch_scc1 K2_FLR
    s_branch K2_E1
K2_FLP1:
    s_cmp_lg_u32 s55, 0
    v_pk_mul_f32 v[224:225], v[30:31], v[196:197] op_sel_hi:[1,0]
    v_pk_mul_f32 v[226:227], v[32:33], v[196:197] op_sel_hi:[1,0]
    v_pk_mul_f32 v[228:229], v[34:35], v[196:197] op_sel_hi:[1,0]
    v_pk_fma_f32 v[224:225], v[46:47], v[196:197], v[224:225] op_sel:[0,1,0] op_sel_hi:[1,1,1]
    v_pk_fma_f32 v[226:227], v[48:49], v[196:197], v[226:227] op_sel:[0,1,0] op_sel_hi:[1,1,1]
    v_pk_fma_f32 v[228:229], v[50:51], v[196:197], v[228:229] op_sel:[0,1,0] op_sel_hi:[1,1,1]
    v_pk_fma_f32 v[224:225], v[62:63], v[198:199], v[224:225] op_sel:[0,0,0] op_sel_hi:[1,0,1]
    v_pk_fma_f32 v[226:227], v[64:65], v[198:199], v[226:227] op_sel:[0,0,0] op_sel_hi:[1,0,1]
    v_pk_fma_f32 v[228:229], v[66:67], v[198:199], v[228:229] op_sel:[0,0,0] op_sel_hi:[1,0,1]
    v_pk_fma_f32 v[224:225], v[78:79], v[198:199], v[224:225] op_sel:[0,1,0] op_sel_hi:[1,1,1]
    v_pk_fma_f32 v[226:227], v[80:81], v[198:199], v[226:227] op_sel:[0,1,0] op_sel_hi:[1,1,1]
    v_pk_fma_f32 v[228:229], v[82:83], v[198:199], v[228:229] op_sel:[0,1,0] op_sel_hi:[1,1,1]
    s_cbranch_scc1 K2_FLM1
K2_FLN1:
    v_mfma_f32_4x4x4_16b_bf16 v[32:35], v[184:185], v[184:185], 0
    v_cvt_pk_bf16_f32 v230, v28, v44
    v_cvt_pk_bf16_f32 v232, v29, v45
    v_mfma_f32_4x4x4_16b_bf16 v[48:51], v[184:185], v[184:185], 0
    ds_write2_b32 v244, v230, v232 offset0:0 offset1:68
    v_mfma_f32_4x4x4_16b_bf16 v[64:67], v[184:185], v[184:185], 0
    v_cvt_pk_bf16_f32 v231, v60, v76
    v_cvt_pk_bf16_f32 v233, v61, v77
    v_mfma_f32_4x4x4_16b_bf16 v[80:83], v[184:185], v[184:185], 0
    ds_write2_b32 v244, v231, v233 offset0:32 offset1:100
    v_cvt_pk_bf16_f32 v224, v224, v225
    v_mfma_f32_4x4x4_16b_bf16 v[28:31], v[184:185], v[184:185], 0
    v_cvt_pk_bf16_f32 v226, v226, v227
    v_mfma_f32_4x4x4_16b_bf16 v[44:47], v[184:185], v[184:185], 0
    ds_write2_b32 v244, v224, v226 offset0:132 offset1:164
    v_cvt_pk_bf16_f32 v228, v228, v229
    v_mfma_f32_4x4x4_16b_bf16 v[60:63], v[184:185], v[184:185], 0
    ds_write_b32 v244, v228 offset:784
    ds_write_b32 v15, v222 offset:42752
    s_cmp_lg_u32 s54, 0
    v_mfma_f32_4x4x4_16b_bf16 v[76:79], v[184:185], v[184:185], 0
    s_cbranch_scc1 K2_FLR
K2_E1:
    s_bitcmp1_b32 s60, s49
    s_cbranch_scc1 K2_BATCH
K2_E2:
    s_bitcmp1_b32 s61, s49
    s_cbranch_scc1 K2_RARE
K2_E3:
    s_bitcmp0_b32 s51, s49
    s_cbranch_scc1 K2_L2
    s_mov_b32 s63, m0
    s_add_u32 s62, s50, 2
    s_lshl_b32 m0, s62, 9
    s_add_u32 s50, s50, 1
    s_bitcmp1_b32 s50, 0
    s_cbranch_scc1 K2_INC1
    ds_read_addtid_b32 v189 offset:0
    ds_read_addtid_b32 v193 offset:256
    s_mov_b32 m0, s63
    s_lshr_b32 s53, s50, 1
    s_sub_u32 s53, s53, 1
    s_add_u32 s52, s49, 1
    s_bitset1_b32 s59, s52
    s_branch K2_L2
K2_INC1:
    ds_read_addtid_b32 v188 offset:0
    ds_read_addtid_b32 v192 offset:256
    s_mov_b32 m0, s63
    s_branch K2_L2
K2_BATCH:
    ds_write_b64 v19, v[184:185]
    ds_write_b64 v19, v[184:185] offset:2176
    v_lshlrev_b32 v210, 16, v209
    s_mov_b64 exec, s[82:83]
    v_mov_b32 v210, s85
    s_mov_b64 exec, -1
    v_and_b32 v209, 0xffff0000, v208
    v_lshlrev_b32 v208, 16, v208
    v_sub_f32 v212, v212, v208
    v_sub_f32 v213, v213, v209
    v_sub_f32 v214, v214, v210
    v_cvt_pk_bf16_f32 v224, v212, v213
    v_cvt_pk_bf16_f32 v225, v214, 0
    v_add_u32_sdwa v227, v5, v10 dst_sel:DWORD dst_unused:UNUSED_PAD src0_sel:DWORD src1_sel:BYTE_1
    v_dot2_f32_bf16 v226, v225, v225, 0
    v_dot2_f32_bf16 v226, v224, v224, v226
    v_lshlrev_b64 v[228:229], v11, v[222:223]
    v_and_b32 v19, -8, v227
    s_mov_b64 exec, s[70:71]
    ds_write_b16 v227, v222
    ds_write_b16 v227, v224 offset:4
    ds_write_b16_d16_hi v227, v224 offset:2176
    ds_write_b16 v227, v225 offset:2180
    s_mov_b64 exec, -1
    v_cvt_pk_bf16_f32 v230, v226, v10
    v_cvt_pk_bf16_f32 v231, v226, v10
    ds_write_b128 v4, v[228:231]
    v_lshl_add_u64 v[16:17], v[16:17], 0, s[76:77]
    s_add_u32 s62, s49, 4
    s_cmp_ge_u32 s62, s47
    s_cbranch_scc1 K2_E2
    v_dot2_f32_bf16 v232, v8, s67, v12
    v_lshlrev_b32_sdwa v11, 3, v9 dst_sel:DWORD dst_unused:UNUSED_PAD src0_sel:DWORD src1_sel:BYTE_0
    v_cmp_gt_u32 vcc, 0x437f0000, v8
    v_mov_b32 v10, v9
    v_and_b32 v232, 0x7fffff, v232
    buffer_load_dwordx2 v[208:209], v232, s[28:31], 0 offen
    v_cmp_eq_u32 s[82:83], s84, v232
    ds_read_b96 v[212:214], v11 offset:43264
    s_mov_b64 s[70:71], vcc
    ds_read_addtid_b32 v8 offset:25536
    ds_read_addtid_b32 v9 offset:34240
    s_branch K2_E2
K2_FLM0:
    v_dot2_f32_bf16 v20, v208, s68, v20
    v_dot2_f32_bf16 v36, v208, s69, v36
    v_dot2_f32_bf16 v52, v209, s68, v52
    v_dot2_f32_bf16 v68, v209, s69, v68
    v_dot2_f32_bf16 v21, v210, s68, v21
    v_dot2_f32_bf16 v37, v210, s69, v37
    v_dot2_f32_bf16 v53, v211, s68, v53
    v_dot2_f32_bf16 v69, v211, s69, v69
    v_dot2_f32_bf16 v224, v212, s68, v224
    v_dot2_f32_bf16 v225, v212, s69, v225
    v_dot2_f32_bf16 v226, v213, s68, v226
    v_dot2_f32_bf16 v227, v213, s69, v227
    v_dot2_f32_bf16 v228, v214, s68, v228
    v_dot2_f32_bf16 v229, v214, s69, v229
    s_branch K2_FLN0
K2_FLM1:
    v_dot2_f32_bf16 v28, v208, s68, v28
    v_dot2_f32_bf16 v44, v208, s69, v44
    v_dot2_f32_bf16 v60, v209, s68, v60
    v_dot2_f32_bf16 v76, v209, s69, v76
    v_dot2_f32_bf16 v29, v210, s68, v29
    v_dot2_f32_bf16 v45, v210, s69, v45
    v_dot2_f32_bf16 v61, v211, s68, v61
    v_dot2_f32_bf16 v77, v211, s69, v77
    v_dot2_f32_bf16 v224, v212, s68, v224
    v_dot2_f32_bf16 v225, v212, s69, v225
    v_dot2_f32_bf16 v226, v213, s68, v226
    v_dot2_f32_bf16 v227, v213, s69, v227
    v_dot2_f32_bf16 v228, v214, s68, v228
    v_dot2_f32_bf16 v229, v214, s69, v229
    s_branch K2_FLN1
K2_RARE:
    s_cmp_lg_u32 s49, 2
    s_cbranch_scc1 K2_RA1
    v_dot2_f32_bf16 v235, v8, s67, v12
    v_lshlrev_b32_sdwa v11, 3, v9 dst_sel:DWORD dst_unused:UNUSED_PAD src0_sel:DWORD src1_sel:BYTE_0
    v_cmp_gt_u32 vcc, 0x437f0000, v8
    v_mov_b32 v10, v9
    v_and_b32 v235, 0x7fffff, v235
    buffer_load_dwordx2 v[208:209], v235, s[28:31], 0 offen
    v_cmp_eq_u32 s[82:83], s84, v235
    ds_read_b96 v[212:214], v11 offset:43264
    s_mov_b64 s[70:71], vcc
    ds_read_addtid_b32 v8 offset:25408
    ds_read_addtid_b32 v9 offset:34112
    s_branch K2_E3
K2_RA1:
    s_lshl_b32 m0, s46, 6
    s_cmp_lt_u32 s49, s47
    s_cbranch_scc1 K2_E3
    s_cmp_lg_u32 s44, 0
    s_cbranch_scc1 K2_L2
    s_mul_i32 s63, s40, 5248
    s_add_u32 m0, s63, 72448
    s_lshl_b32 s63, s40, 12
    s_add_u32 s63, s63, 0xd480000
    v_lshlrev_b32 v234, 4, v1
    s_waitcnt lgkmcnt(0)
    buffer_load_dwordx4 v234, s[32:35], s63 offen offset:0 sc1 lds
    buffer_load_dwordx4 v234, s[32:35], s63 offen offset:1024 sc1 lds
    buffer_load_dwordx4 v234, s[32:35], s63 offen offset:2048 sc1 lds
    buffer_load_dwordx4 v234, s[32:35], s63 offen offset:3072 sc1 lds
    buffer_load_dword v164, v246, s[36:39], s87 offen offset:0
    buffer_load_dword v165, v246, s[36:39], s87 offen offset:256
    buffer_load_dword v166, v246, s[36:39], s87 offen offset:512
    buffer_load_dword v167, v246, s[36:39], s87 offen offset:768
    buffer_load_dword v168, v246, s[36:39], s87 offen offset:2048
    buffer_load_dword v169, v246, s[36:39], s87 offen offset:2304
    buffer_load_dword v170, v246, s[36:39], s87 offen offset:2560
    buffer_load_dword v171, v246, s[36:39], s87 offen offset:2816
    buffer_load_dword v172, v246, s[36:39], s88 offen offset:0
    buffer_load_dword v173, v246, s[36:39], s88 offen offset:256
    buffer_load_dword v174, v246, s[36:39], s88 offen offset:512
    buffer_load_dword v175, v246, s[36:39], s88 offen offset:768
    buffer_load_dword v176, v246, s[36:39], s88 offen offset:2048
    buffer_load_dword v177, v246, s[36:39], s88 offen offset:2304
    buffer_load_dword v178, v246, s[36:39], s88 offen offset:2560
    buffer_load_dword v179, v246, s[36:39], s88 offen offset:2816
    s_branch K2_L2
K2_G9:
    s_lshr_b32 s62, s46, 2
    s_and_b32 s63, s46, 3
    s_lshr_b32 s64, s46, 3
    s_add_u32 s64, s64, 1
    s_and_b32 s65, s62, 1
    s_mov_b32 s48, 0
    s_cmp_lt_u32 s40, 4
    s_cbranch_scc1 K2_R9
    s_mul_i32 s48, s63, s65
    s_lshl2_add_u32 s48, s64, s48
    s_sub_u32 s64, s62, s64
    s_xor_b32 s65, s65, 1
K2_R9:
    s_and_b32 s62, s40, 3
    s_mul_i32 s66, s62, s64
    s_add_u32 s48, s48, s66
    s_min_u32 s66, s62, s63
    s_mul_i32 s66, s66, s65
    s_add_u32 s48, s48, s66
    s_cmp_lt_u32 s62, s63
    s_cselect_b32 s65, s65, 0
    s_add_u32 s47, s64, s65
    s_cmp_lg_u32 s56, 0
    s_cbranch_scc1 K2_R7
    s_mov_b32 s60, 1048576
K2_G7:
    s_waitcnt vmcnt(0)
    v_cmp_ne_u64 vcc, s[80:81], v[230:231]
    s_sub_u32 s60, s60, 1
    s_cselect_b64 exec, 0, vcc
    s_cbranch_execz K2_G7_OK
    buffer_load_dwordx2 v[230:231], v235, s[32:35], s59 offen sc1
    s_branch K2_G7
K2_G7_OK:
    s_mov_b64 exec, -1
    v_lshlrev_b32 v224, 7, v1
    s_lshr_b32 s62, s2, 3
    s_mul_i32 s62, s62, 3072
    s_mul_i32 s63, s40, 1605632
    s_add_u32 s62, s62, s63
    s_mov_b64 exec, 0xffffff
    s_add_u32 s63, s62, 0xc000000
    buffer_load_dword v233, v224, s[24:27], s63 offen sc1
    s_mov_b64 exec, -1
    s_branch K2_R7
K2_RETRY:
    s_mov_b32 s43, 4
K2_AGAIN:
    s_mov_b32 s54, 1
    s_waitcnt vmcnt(0) lgkmcnt(0)
    s_barrier
    v_lshlrev_b32 v227, 3, v1
    ds_write_b64 v227, v[184:185] offset:42496
    s_waitcnt lgkmcnt(0)
    s_barrier
    s_cmp_lt_u32 s40, 4
    s_cbranch_scc1 K2_GR
    v_and_b32 v247, 255, v0
    v_lshlrev_b32 v243, 4, v1
    s_branch K2_OFF
K2_ACC:
    s_waitcnt vmcnt(0) lgkmcnt(0)
    s_barrier
    v_lshlrev_b32 v104, 4, v0
    v_lshlrev_b32 v105, 5, v0
    v_add_u32 v104, 114432, v104
    s_mul_i32 s62, s2, 98304
    s_add_u32 s62, s62, 0x2000000
    s_add_u32 s63, s62, 98304
K2_AC1:
    ds_read_b128 v[100:103], v104
    v_mov_b32 v92, 0
    v_mov_b32 v93, 0
    v_mov_b32 v94, 0
    v_mov_b32 v95, 0
    v_mov_b32 v96, 0
    v_mov_b32 v97, 0
    v_mov_b32 v98, 0
    v_mov_b32 v99, 0
    s_cmp_eq_u32 s56, 0
    s_cbranch_scc1 K2_AC2
    buffer_load_dwordx4 v[92:95], v105, s[32:35], s62 offen sc1
    buffer_load_dwordx4 v[96:99], v105, s[32:35], s62 offen offset:16 sc1
K2_AC2:
    s_waitcnt vmcnt(0) lgkmcnt(0)
    v_lshlrev_b32 v84, 16, v100
    v_and_b32 v85, 0xffff0000, v100
    v_lshlrev_b32 v86, 16, v101
    v_and_b32 v87, 0xffff0000, v101
    v_lshlrev_b32 v88, 16, v102
    v_and_b32 v89, 0xffff0000, v102
    v_lshlrev_b32 v90, 16, v103
    v_and_b32 v91, 0xffff0000, v103
    v_add_f32 v84, v84, v92
    v_add_f32 v85, v85, v93
    v_add_f32 v86, v86, v94
    v_add_f32 v87, v87, v95
    v_add_f32 v88, v88, v96
    v_add_f32 v89, v89, v97
    v_add_f32 v90, v90, v98
    v_add_f32 v91, v91, v99
    buffer_store_dwordx4 v[84:87], v105, s[32:35], s62 offen sc1
    buffer_store_dwordx4 v[88:91], v105, s[32:35], s62 offen offset:16 sc1
    v_cvt_pk_bf16_f32 v100, v84, v85
    v_cvt_pk_bf16_f32 v101, v86, v87
    v_cvt_pk_bf16_f32 v102, v88, v89
    v_cvt_pk_bf16_f32 v103, v90, v91
    ds_write_b128 v104, v[100:103]
    s_add_u32 s62, s62, 16384
    s_waitcnt vmcnt(0) lgkmcnt(0)
    v_add_u32 v104, 8192, v104
    s_cmp_lt_u32 s62, s63
    s_cbranch_scc1 K2_AC1
    s_cmp_eq_u32 s44, 0
    s_cbranch_scc1 K2_FIN
    s_add_u32 s42, s42, s43
    s_mov_b32 s43, 24
    s_mov_b32 s56, 1
    s_branch K2_AGAIN
K2_FLR:
    s_cmp_eq_u32 s54, 1
    s_cbranch_scc1 K2_D1
    s_or_b32 s62, s44, s56
    s_cbranch_scc1 K2_ACC
K2_FIN:
    s_setprio 0
    v_add_u32 v227, 128, v236
    ds_read2st64_b32 v[116:117], v236 offset0:0 offset1:2
    ds_read2st64_b32 v[118:119], v236 offset0:8 offset1:10
    ds_read2st64_b32 v[120:121], v236 offset0:16 offset1:18
    ds_read2st64_b32 v[122:123], v236 offset0:24 offset1:24
    ds_read2st64_b32 v[124:125], v227 offset0:0 offset1:2
    ds_read2st64_b32 v[126:127], v227 offset0:8 offset1:10
    ds_read2st64_b32 v[128:129], v227 offset0:16 offset1:18
    ds_read2st64_b32 v[130:131], v227 offset0:24 offset1:24
    v_mfma_f32_32x32x8_bf16 v[132:147], v[184:185], v[184:185], 0
    v_mfma_f32_32x32x8_bf16 v[84:99], v[184:185], v[184:185], 0
    v_mfma_f32_32x32x8_bf16 v[148:163], v[184:185], v[184:185], 0
    v_mfma_f32_32x32x8_bf16 v[100:115], v[184:185], v[184:185], 0
K2_F0:
    ds_read_b32 v224, v184 offset:42832
    s_waitcnt lgkmcnt(0)
    v_readfirstlane_b32 s62, v224
    s_cmp_lt_u32 s62, 130048
    s_cbranch_scc1 K2_F0
    ds_read_b128 v[20:23], v238 offset:0
    ds_read_b128 v[24:27], v238 offset:1024
    ds_read_b128 v[28:31], v238 offset:2048
    ds_read_b128 v[32:35], v238 offset:3072
    ds_read_b128 v[36:39], v238 offset:5248
    ds_read_b128 v[40:43], v238 offset:6272
    ds_read_b128 v[44:47], v238 offset:7296
    ds_read_b128 v[48:51], v238 offset:8320
    v_smfmac_f32_32x32x32_bf16 v[84:99], v[248:251], v[116:123], v247
    ds_read_b128 v[52:55], v238 offset:10496
    ds_read_b128 v[56:59], v238 offset:11520
    ds_read_b128 v[60:63], v238 offset:12544
    ds_read_b128 v[64:67], v238 offset:13568
    ds_read_b128 v[68:71], v238 offset:15744
    ds_read_b128 v[72:75], v238 offset:16768
    ds_read_b128 v[76:79], v238 offset:17792
    ds_read_b128 v[80:83], v238 offset:18816
    v_smfmac_f32_32x32x32_bf16 v[100:115], v[248:251], v[124:131], v247
    s_waitcnt vmcnt(0)
    v_smfmac_f32_32x32x32_bf16 v[132:147], v[180:183], v[164:171], v13
    v_smfmac_f32_32x32x32_bf16 v[148:163], v[180:183], v[172:179], v13
    s_barrier
K2_FB:
    ds_read_b128 v[164:167], v237 offset:0
    ds_read_b128 v[168:171], v237 offset:32
    ds_read_b128 v[172:175], v237 offset:64
    ds_read_b128 v[176:179], v237 offset:96
    ds_read_b128 v[116:119], v237 offset:128
    ds_read_b128 v[120:123], v237 offset:160
    ds_read_b128 v[124:127], v237 offset:192
    ds_read_b128 v[128:131], v237 offset:224
    ds_read_b128 v[208:211], v239 offset:528
    ds_read_b128 v[212:215], v239 offset:560
    ds_read_b128 v[200:203], v239 offset:592
    ds_read_b128 v[204:207], v239 offset:624
    ds_read2_b32 v[228:229], v241 offset0:0 offset1:4
    s_waitcnt lgkmcnt(11)
    v_mfma_f32_32x32x16_bf16 v[84:99], v[164:167], v[20:23], v[84:99]
    v_mfma_f32_32x32x16_bf16 v[84:99], v[168:171], v[24:27], v[84:99]
    s_waitcnt lgkmcnt(9)
    v_mfma_f32_32x32x16_bf16 v[84:99], v[172:175], v[28:31], v[84:99]
    v_mfma_f32_32x32x16_bf16 v[84:99], v[176:179], v[32:35], v[84:99]
    s_waitcnt lgkmcnt(7)
    v_mfma_f32_32x32x16_bf16 v[84:99], v[116:119], v[36:39], v[84:99]
    v_mfma_f32_32x32x16_bf16 v[84:99], v[120:123], v[40:43], v[84:99]
    s_waitcnt lgkmcnt(5)
    v_mfma_f32_32x32x16_bf16 v[84:99], v[124:127], v[44:47], v[84:99]
    v_mfma_f32_32x32x16_bf16 v[84:99], v[128:131], v[48:51], v[84:99]
    v_mfma_f32_32x32x16_bf16 v[100:115], v[164:167], v[52:55], v[100:115]
    s_mov_b32 s24, s20
    s_mov_b32 s25, s21
    s_mov_b32 s26, 0x61a800
    s_mov_b32 s27, 0x20000
    s_mov_b32 s74, 0x3f805879
    v_add_u32 v227, 128, v242
    v_mfma_f32_32x32x16_bf16 v[100:115], v[168:171], v[56:59], v[100:115]
    s_add_u32 s28, s20, 0x61a800
    s_addc_u32 s29, s21, 0
    s_mov_b32 s30, 0x249f0
    s_mov_b32 s31, 0x20000
    s_mov_b32 s72, 0x3fb8aa3b
    s_mov_b32 s73, 0x3fb8aa3b
    v_mfma_f32_32x32x16_bf16 v[100:115], v[172:175], v[60:63], v[100:115]
    v_mul_f32 v84, s74, v84
    v_mul_f32 v85, s74, v85
    v_exp_f32 v20, -v84
    v_exp_f32 v21, -v85
    v_mfma_f32_32x32x16_bf16 v[100:115], v[176:179], v[64:67], v[100:115]
    v_mul_f32 v86, s74, v86
    v_mul_f32 v87, s74, v87
    v_exp_f32 v22, -v86
    v_exp_f32 v23, -v87
    v_mfma_f32_32x32x16_bf16 v[100:115], v[116:119], v[68:71], v[100:115]
    v_mul_f32 v88, s74, v88
    v_mul_f32 v89, s74, v89
    v_exp_f32 v24, -v88
    v_exp_f32 v25, -v89
    v_mfma_f32_32x32x16_bf16 v[100:115], v[120:123], v[72:75], v[100:115]
    v_mul_f32 v90, s74, v90
    v_mul_f32 v91, s74, v91
    v_exp_f32 v26, -v90
    v_exp_f32 v27, -v91
    v_mfma_f32_32x32x16_bf16 v[100:115], v[124:127], v[76:79], v[100:115]
    v_mul_f32 v92, s74, v92
    v_mul_f32 v93, s74, v93
    v_exp_f32 v28, -v92
    v_exp_f32 v29, -v93
    v_mfma_f32_32x32x16_bf16 v[100:115], v[128:131], v[80:83], v[100:115]
    v_mul_f32 v94, s74, v94
    v_mul_f32 v95, s74, v95
    v_exp_f32 v30, -v94
    v_exp_f32 v31, -v95
    s_waitcnt lgkmcnt(0)
    v_mfma_f32_32x32x16_bf16 v[36:51], v[252:255], v[208:211], 0
    v_fma_f32 v20, v20, s72, s72
    v_fma_f32 v21, v21, s72, s72
    v_fma_f32 v22, v22, s72, s72
    v_rcp_f32 v20, v20
    v_rcp_f32 v21, v21
    v_rcp_f32 v22, v22
    v_mfma_f32_32x32x16_bf16 v[36:51], v[252:255], v[212:215], v[36:51]
    v_fma_f32 v23, v23, s72, s72
    v_fma_f32 v24, v24, s72, s72
    v_fma_f32 v25, v25, s72, s72
    v_rcp_f32 v23, v23
    v_rcp_f32 v24, v24
    v_rcp_f32 v25, v25
    v_mfma_f32_32x32x16_bf16 v[36:51], v[252:255], v[200:203], v[36:51]
    v_fma_f32 v26, v26, s72, s72
    v_fma_f32 v27, v27, s72, s72
    v_fma_f32 v28, v28, s72, s72
    v_rcp_f32 v26, v26
    v_rcp_f32 v27, v27
    v_rcp_f32 v28, v28
    v_mfma_f32_32x32x16_bf16 v[36:51], v[252:255], v[204:207], v[36:51]
    v_fma_f32 v29, v29, s72, s72
    v_fma_f32 v30, v30, s72, s72
    v_fma_f32 v31, v31, s72, s72
    v_rcp_f32 v29, v29
    v_rcp_f32 v30, v30
    v_rcp_f32 v31, v31
    v_mul_f32 v100, s74, v100
    v_mul_f32 v101, s74, v101
    v_mul_f32 v102, s74, v102
    v_mul_f32 v103, s74, v103
    v_exp_f32 v52, -v100
    v_exp_f32 v53, -v101
    v_exp_f32 v54, -v102
    v_exp_f32 v55, -v103
    v_fma_f32 v52, v52, s72, s72
    v_fma_f32 v53, v53, s72, s72
    v_fma_f32 v54, v54, s72, s72
    v_fma_f32 v55, v55, s72, s72
    v_rcp_f32 v52, v52
    v_rcp_f32 v53, v53
    v_rcp_f32 v54, v54
    v_rcp_f32 v55, v55
    v_pk_fma_f32 v[84:85], v[84:85], v[20:21], v[132:133]
    v_pk_fma_f32 v[86:87], v[86:87], v[22:23], v[134:135]
    v_pk_fma_f32 v[100:101], v[100:101], v[52:53], v[140:141]
    v_pk_fma_f32 v[102:103], v[102:103], v[54:55], v[142:143]
    v_cvt_pk_bf16_f32 v84, v84, v100
    v_cvt_pk_bf16_f32 v85, v85, v101
    v_cvt_pk_bf16_f32 v86, v86, v102
    v_cvt_pk_bf16_f32 v87, v87, v103
    ds_write2st64_b32 v242, v84, v86 offset0:0 offset1:1
    ds_write2st64_b32 v227, v85, v87 offset0:0 offset1:1
    ds_read_b128 v[164:167], v243 offset:0
    v_mul_f32 v104, s74, v104
    v_mul_f32 v105, s74, v105
    v_mul_f32 v106, s74, v106
    v_mul_f32 v107, s74, v107
    v_exp_f32 v56, -v104
    v_exp_f32 v57, -v105
    v_exp_f32 v58, -v106
    v_exp_f32 v59, -v107
    v_fma_f32 v56, v56, s72, s72
    v_fma_f32 v57, v57, s72, s72
    v_fma_f32 v58, v58, s72, s72
    v_fma_f32 v59, v59, s72, s72
    v_rcp_f32 v56, v56
    v_rcp_f32 v57, v57
    v_rcp_f32 v58, v58
    v_rcp_f32 v59, v59
    s_waitcnt lgkmcnt(0)
    buffer_store_dwordx4 v[164:167], v245, s[24:27], s87 offen offset:0 sc1
    v_pk_fma_f32 v[88:89], v[88:89], v[24:25], v[136:137]
    v_pk_fma_f32 v[90:91], v[90:91], v[26:27], v[138:139]
    v_pk_fma_f32 v[104:105], v[104:105], v[56:57], v[144:145]
    v_pk_fma_f32 v[106:107], v[106:107], v[58:59], v[146:147]
    v_cvt_pk_bf16_f32 v88, v88, v104
    v_cvt_pk_bf16_f32 v89, v89, v105
    v_cvt_pk_bf16_f32 v90, v90, v106
    v_cvt_pk_bf16_f32 v91, v91, v107
    ds_write2st64_b32 v242, v88, v90 offset0:4 offset1:5
    ds_write2st64_b32 v227, v89, v91 offset0:4 offset1:5
    ds_read_b128 v[168:171], v243 offset:1024
    v_mul_f32 v108, s74, v108
    v_mul_f32 v109, s74, v109
    v_mul_f32 v110, s74, v110
    v_mul_f32 v111, s74, v111
    v_exp_f32 v60, -v108
    v_exp_f32 v61, -v109
    v_exp_f32 v62, -v110
    v_exp_f32 v63, -v111
    v_fma_f32 v60, v60, s72, s72
    v_fma_f32 v61, v61, s72, s72
    v_fma_f32 v62, v62, s72, s72
    v_fma_f32 v63, v63, s72, s72
    v_rcp_f32 v60, v60
    v_rcp_f32 v61, v61
    v_rcp_f32 v62, v62
    v_rcp_f32 v63, v63
    s_waitcnt lgkmcnt(0)
    buffer_store_dwordx4 v[168:171], v245, s[24:27], s87 offen offset:2048 sc1
    v_pk_fma_f32 v[92:93], v[92:93], v[28:29], v[148:149]
    v_pk_fma_f32 v[94:95], v[94:95], v[30:31], v[150:151]
    v_pk_fma_f32 v[108:109], v[108:109], v[60:61], v[156:157]
    v_pk_fma_f32 v[110:111], v[110:111], v[62:63], v[158:159]
    v_cvt_pk_bf16_f32 v92, v92, v108
    v_cvt_pk_bf16_f32 v93, v93, v109
    v_cvt_pk_bf16_f32 v94, v94, v110
    v_cvt_pk_bf16_f32 v95, v95, v111
    ds_write2st64_b32 v242, v92, v94 offset0:8 offset1:9
    ds_write2st64_b32 v227, v93, v95 offset0:8 offset1:9
    ds_read_b128 v[172:175], v243 offset:2048
    s_cmp_gt_u32 s40, 4
    s_cbranch_scc1 K2_F2
    v_add_f32 v228, v228, v36
    v_add_f32 v229, v229, v37
    v_cvt_pk_bf16_f32 v228, v228, v229
    s_mul_i32 s62, s41, 6
    s_mov_b64 exec, s[78:79]
    buffer_store_short v228, v240, s[28:31], s62 offen
    buffer_store_short_d16_hi v228, v240, s[28:31], s62 offen offset:6
    s_mov_b64 exec, -1
K2_F2:
    s_waitcnt lgkmcnt(0)
    buffer_store_dwordx4 v[172:175], v245, s[24:27], s88 offen offset:0 sc1
    s_cmp_lg_u32 s86, 3
    s_cbranch_scc1 K2_F3
    v_mul_f32 v96, s74, v96
    v_mul_f32 v97, s74, v97
    v_mul_f32 v112, s74, v112
    v_mul_f32 v113, s74, v113
    v_exp_f32 v32, -v96
    v_exp_f32 v33, -v97
    v_exp_f32 v64, -v112
    v_exp_f32 v65, -v113
    v_fma_f32 v32, v32, s72, s72
    v_fma_f32 v33, v33, s72, s72
    v_fma_f32 v64, v64, s72, s72
    v_fma_f32 v65, v65, s72, s72
    v_rcp_f32 v32, v32
    v_rcp_f32 v33, v33
    v_rcp_f32 v64, v64
    v_rcp_f32 v65, v65
    v_pk_fma_f32 v[96:97], v[96:97], v[32:33], v[152:153]
    v_pk_fma_f32 v[112:113], v[112:113], v[64:65], v[160:161]
    v_cvt_pk_bf16_f32 v96, v96, v112
    v_cvt_pk_bf16_f32 v97, v97, v113
    ds_write_b32 v242, v96 offset:3072
    ds_write_b32 v242, v97 offset:3200
    ds_read_b128 v[176:179], v243 offset:3072
    s_mov_b64 exec, 0xffff
    s_waitcnt lgkmcnt(0)
    buffer_store_dwordx4 v[176:179], v245, s[24:27], s88 offen offset:2048 sc1
K2_F3:
    s_or_b32 s62, s2, s40
    s_cbranch_scc1 K2_F4
    v_mov_b32 v224, s80
    v_mov_b32 v225, s81
    s_mov_b32 s62, 0xd600000
    s_mov_b64 exec, 1
    buffer_store_dwordx2 v[224:225], v184, s[32:35], s62 offen sc1
K2_F4:
K2_END:
    s_endpgm

.section .rodata,"a"
.p2align 6
.amdhsa_kernel standalone__cheap_equivariant_egnn__graph_kernel
  .amdhsa_next_free_vgpr 256
  .amdhsa_next_free_sgpr 89
  .amdhsa_accum_offset 256
  .amdhsa_group_segment_fixed_size 0
  .amdhsa_kernarg_size 88
  .amdhsa_user_sgpr_count 2
  .amdhsa_user_sgpr_kernarg_segment_ptr 1
  .amdhsa_system_sgpr_workgroup_id_x 1
.end_amdhsa_kernel
```
